```python
import torch

def _softmax(x, axis=-1):
    return torch.softmax(x, dim=axis)
def _gelu(x):
    return torch.nn.functional.gelu(x, approximate="tanh")
def _silu(x):
    return torch.nn.functional.silu(x)
def _sigmoid(x):
    return torch.sigmoid(x)
def _layernorm(x, axis=-1, eps=1e-5):
    m = x.mean(dim=axis, keepdim=True)
    v = x.var(dim=axis, keepdim=True, unbiased=False)
    return (x - m) / torch.sqrt(v + eps)
def _scatter_add(tgt, idx, src, axis=0):
    return tgt.clone().index_add_(axis, idx, src)
def _segment_sum(src, seg, n):
    out = torch.zeros((n,) + src.shape[1:], dtype=src.dtype)
    return out.index_add_(0, seg, src)
def _pad(x, pw):
    flat = tuple(v for pair in reversed(pw) for v in pair)
    return torch.nn.functional.pad(x, flat)

kernel_name = 'sequential_preLN__spectral_fnet__dense_activation_relu__prompt'

def setup_inputs():

    _w = (lambda a: (lambda t: t.to(torch.bfloat16) if t.is_floating_point() else t)(torch.as_tensor(a)))
    def _A_setup():
        B, S, D = 1, 2048, 448
        ns = torch.arange(S)[:, None] * torch.arange(S)[None, :]
        nd = torch.arange(D)[:, None] * torch.arange(D)[None, :]
        Ws_re = torch.cos(-2.0 * torch.pi * ns / S).to(float)
        Ws_im = torch.sin(-2.0 * torch.pi * ns / S).to(float)
        Wd_re = torch.cos(-2.0 * torch.pi * nd / D).to(float)
        Wd_im = torch.sin(-2.0 * torch.pi * nd / D).to(float)
        return {
            "x": _w((lambda *s: torch.randn(*s, dtype=torch.bfloat16) * 0.05)(B, S, D)),
            "dft_seq_re": _w(Ws_re),
            "dft_seq_im": _w(Ws_im),
            "dft_hid_re": _w(Wd_re),
            "dft_hid_im": _w(Wd_im),
        }
    _A_in = _A_setup()

    def _B_setup():
        B, S, D, Dff = 1, 2048, 448, 1792
        return {
            "x": _w((lambda *s: torch.randn(*s, dtype=torch.bfloat16) * 0.05)(B, S, D)),
            "w1": _w((lambda *s: torch.randn(*s, dtype=torch.bfloat16) * 0.4)(D, Dff)),
            "w2": _w((lambda *s: torch.randn(*s, dtype=torch.bfloat16) * 0.4)(Dff, D)),
        }
    _B_in = _B_setup()

    return {
        "A_x": _A_in["x"],
        "A_dft_seq_re": _A_in["dft_seq_re"],
        "A_dft_seq_im": _A_in["dft_seq_im"],
        "A_dft_hid_re": _A_in["dft_hid_re"],
        "A_dft_hid_im": _A_in["dft_hid_im"],
        "B_x": _B_in["x"],
        "B_w1": _B_in["w1"],
        "B_w2": _B_in["w2"],
    }

def reference(A_x, A_dft_seq_re, A_dft_seq_im, A_dft_hid_re, A_dft_hid_im, B_x, B_w1, B_w2):
    def _A_ref(x, dft_seq_re, dft_seq_im, dft_hid_re, dft_hid_im):
        a = torch.einsum("bsd,ed->bse", x, dft_hid_re)
        b = torch.einsum("bsd,ed->bse", x, dft_hid_im)
        y = torch.einsum("ts,bse->bte", dft_seq_re, a) - torch.einsum("ts,bse->bte", dft_seq_im, b)
        return y

    def _B_ref(x, w1, w2):
        h = torch.einsum("bsd,df->bsf", x, w1)
        zero = torch.zeros_like(h)
        h = torch.maximum(h, zero)
        return torch.einsum("bsf,fd->bsd", h, w2)

    x = A_x
    h = x + _A_ref(_layernorm(x, axis=-1), A_dft_seq_re, A_dft_seq_im, A_dft_hid_re, A_dft_hid_im)
    h2 = h + _B_ref(_layernorm(h, axis=-1), B_w1, B_w2)
    return h2
```

```asm
; @launch grid=(252,1,1) block=(256,1,1) lds=158464
.amdgcn_target "amdgcn-amd-amdhsa--gfx950"
.text
.globl sequential_preLN__spectral_fnet__dense_activation_relu__prompt_kernel
.p2align 8
.type sequential_preLN__spectral_fnet__dense_activation_relu__prompt_kernel,@function
sequential_preLN__spectral_fnet__dense_activation_relu__prompt_kernel:
    s_cmp_ge_u32 s2, 252
    s_cbranch_scc1 L_end
    s_load_dwordx2 s[16:17], s[0:1], 0
    s_load_dwordx8 s[28:35], s[0:1], 48
    s_load_dwordx2 s[36:37], s[0:1], 80
    s_getpc_b64 s[6:7]
L_pc:
    v_lshlrev_b32 v2, 7, v0
    v_mov_b32 v5, s7
    v_add_co_u32 v4, vcc, s6, v2
    s_nop 1
    v_addc_co_u32 v5, vcc, 0, v5, vcc
    v_cmp_gt_u32 vcc, L_code_end-L_pc, v2
    s_nop 1
    s_and_saveexec_b64 s[8:9], vcc
    s_cbranch_execz L_nopf_1
    global_load_dword a255, v[4:5], off
L_nopf_1:
    s_mov_b64 exec, s[8:9]
    v_mov_b32 v9, v0
    v_lshrrev_b32 v1, 6, v0
    v_and_b32 v0, 63, v0
    v_readfirstlane_b32 s3, v1
    s_cmp_ge_u32 s2, 224
    s_cbranch_scc1 L_cs
    s_and_b32 s6, s2, 7
    s_lshr_b32 s7, s2, 3
    s_mul_i32 s8, s7, 37
    s_lshr_b32 s8, s8, 8
    s_mul_i32 s9, s8, 7
    s_sub_u32 s5, s7, s9
    s_lshl_b32 s8, s8, 3
    s_add_u32 s4, s6, s8
    v_and_b32 v1, 15, v0
    v_lshrrev_b32 v2, 4, v0
    v_lshlrev_b32 v30, 4, v0
    v_lshrrev_b32 v4, 3, v0
    v_and_b32 v5, 7, v0
    v_xor_b32 v5, v5, v4
    v_lshlrev_b32 v5, 4, v5
    v_mul_u32_u24 v228, 28672, v4
    v_add_u32 v228, v228, v5
    s_lshl_b32 s6, s3, 9
    s_add_u32 s6, s6, s4
    s_mul_i32 s12, s6, 896
    s_add_u32 s13, s12, 229376
    s_lshl_b32 s11, s3, 11
    s_lshr_b32 s6, s3, 1
    s_lshl_b32 s7, s5, 1
    s_add_u32 s8, s6, s7
    s_and_b32 s9, s3, 1
    s_lshl_b32 s6, s8, 12
    s_lshl_b32 s7, s4, 7
    s_add_u32 s6, s6, s7
    s_lshl_b32 s7, s9, 6
    s_add_u32 s10, s6, s7
    v_mul_u32_u24 v229, 57344, v1
    v_lshl_add_u32 v229, v2, 4, v229
    s_waitcnt lgkmcnt(0)
    s_mov_b32 s40, s16
    s_mov_b32 s41, s17
    s_mov_b32 s42, 0x1c0000
    s_mov_b32 s43, 0x00020000
    s_mov_b32 s52, s36
    s_mov_b32 s53, s37
    s_mov_b32 s54, 0x10000000
    s_mov_b32 s55, 0x00020000
    v_mov_b32 v60, -1
    v_mov_b32 v61, -1
    v_mov_b32 v62, -1
    v_mov_b32 v63, -1
    s_add_u32 s7, s10, 917504
    buffer_store_dwordx4 v[60:63], v229, s[52:55], s10 offen sc1
    buffer_store_dwordx4 v[60:63], v229, s[52:55], s7 offen sc1
    s_mul_i32 s6, s4, 7
    s_add_u32 s6, s6, s5
    s_lshl_b32 s6, s6, 2
    s_add_u32 s6, s6, s3
    s_lshl_b32 s6, s6, 7
    s_add_u32 s6, s6, 2228224
    v_mov_b32 v4, 0
    s_mov_b64 exec, 1
    buffer_store_dword v4, v4, s[52:55], s6 offen sc1
    s_mov_b64 exec, -1
    s_add_u32 m0, s11, 0
    s_nop 0
    buffer_load_dwordx4 v228, s[40:43], s12 offen offset:0  lds
    s_add_u32 m0, s11, 1024
    s_nop 0
    buffer_load_dwordx4 v228, s[40:43], s13 offen offset:0  lds
    s_add_u32 m0, s11, 8064
    s_nop 0
    buffer_load_dwordx4 v228, s[40:43], s12 offen offset:128  lds
    s_add_u32 m0, s11, 9088
    s_nop 0
    buffer_load_dwordx4 v228, s[40:43], s13 offen offset:128  lds
    s_add_u32 m0, s11, 16128
    s_nop 0
    buffer_load_dwordx4 v228, s[40:43], s12 offen offset:256  lds
    s_add_u32 m0, s11, 17152
    s_nop 0
    buffer_load_dwordx4 v228, s[40:43], s13 offen offset:256  lds
    s_add_u32 m0, s11, 24192
    s_nop 0
    buffer_load_dwordx4 v228, s[40:43], s12 offen offset:384  lds
    s_add_u32 m0, s11, 25216
    s_nop 0
    buffer_load_dwordx4 v228, s[40:43], s13 offen offset:384  lds
    s_add_u32 m0, s11, 32256
    s_nop 0
    buffer_load_dwordx4 v228, s[40:43], s12 offen offset:512  lds
    s_add_u32 m0, s11, 33280
    s_nop 0
    buffer_load_dwordx4 v228, s[40:43], s13 offen offset:512  lds
    s_add_u32 m0, s11, 40320
    s_nop 0
    buffer_load_dwordx4 v228, s[40:43], s12 offen offset:640  lds
    s_add_u32 m0, s11, 41344
    s_nop 0
    buffer_load_dwordx4 v228, s[40:43], s13 offen offset:640  lds
    s_add_u32 m0, s11, 48384
    s_nop 0
    buffer_load_dwordx4 v228, s[40:43], s12 offen offset:768  lds
    s_add_u32 m0, s11, 49408
    s_nop 0
    buffer_load_dwordx4 v228, s[40:43], s13 offen offset:768  lds
    s_mov_b32 s44, s28
    s_mov_b32 s45, s29
    s_mov_b32 s46, 0x188000
    s_mov_b32 s47, 0x00020000
    s_mov_b32 s48, s30
    s_mov_b32 s49, s31
    s_mov_b32 s50, 0x188000
    s_mov_b32 s51, 0x00020000
    s_mov_b32 s56, s32
    s_mov_b32 s57, s33
    s_mov_b32 s58, 0x1c0000
    s_mov_b32 s59, 0x00020000
    s_mov_b32 s60, s34
    s_mov_b32 s61, s35
    s_mov_b32 s62, 0x100
    s_mov_b32 s63, 0x00020000
    v_and_b32 v4, 7, v1
    v_lshrrev_b32 v5, 3, v1
    v_lshlrev_b32 v5, 10, v5
    v_lshl_add_u32 v5, v4, 7, v5
    v_mov_b32 v6, v2
    v_xor_b32 v6, v6, v4
    v_lshl_add_u32 v7, v6, 4, v5
    v_add_u32 v6, 4, v2
    v_xor_b32 v6, v6, v4
    v_lshl_add_u32 v8, v6, 4, v5
    v_lshlrev_b32 v9, 4, v2
    s_lshl_b32 s6, s3, 11
    v_add_u32 v216, s6, v7
    v_add_u32 v217, s6, v8
    s_lshr_b32 s6, s6, 5
    s_add_u32 s6, s6, 157696
    v_add_u32 v224, s6, v9
    s_add_u32 s6, s3, 1
    s_and_b32 s6, s6, 3
    s_lshl_b32 s6, s6, 11
    v_add_u32 v218, s6, v7
    v_add_u32 v219, s6, v8
    s_lshr_b32 s6, s6, 5
    s_add_u32 s6, s6, 157696
    v_add_u32 v225, s6, v9
    s_add_u32 s6, s3, 2
    s_and_b32 s6, s6, 3
    s_lshl_b32 s6, s6, 11
    v_add_u32 v220, s6, v7
    v_add_u32 v221, s6, v8
    s_lshr_b32 s6, s6, 5
    s_add_u32 s6, s6, 157696
    v_add_u32 v226, s6, v9
    s_add_u32 s6, s3, 3
    s_and_b32 s6, s6, 3
    s_lshl_b32 s6, s6, 11
    v_add_u32 v222, s6, v7
    v_add_u32 v223, s6, v8
    s_lshr_b32 s6, s6, 5
    s_add_u32 s6, s6, 157696
    v_add_u32 v227, s6, v9
    v_mov_b32 v180, 0x3f803f80
    v_mov_b32 v181, v180
    v_mov_b32 v182, v180
    v_mov_b32 v183, v180
    v_lshrrev_b32 v4, 2, v1
    v_cmp_eq_u32 s[94:95], v4, v2
    v_and_b32 v4, 3, v1
    v_cmp_eq_u32 s[96:97], 1, v4
    v_cmp_eq_u32 s[98:99], 2, v4
    v_cmp_eq_u32 s[100:101], 3, v4
    s_lshr_b32 s6, s3, 1
    s_lshl_b32 s7, s5, 1
    s_add_u32 s8, s6, s7
    s_and_b32 s9, s3, 1
    s_lshl_b32 s6, s8, 4
    s_lshl_b32 s7, s9, 3
    s_add_u32 s6, s6, s7
    v_lshrrev_b32 v4, 1, v1
    v_add_u32 v4, s6, v4
    v_and_b32 v5, 1, v1
    v_lshl_or_b32 v6, v4, 1, v5
    v_mov_b32 v7, 224
    v_cmp_eq_u32 vcc, 1, v6
    v_mov_b32 v8, 0
    s_nop 0
    v_cndmask_b32 v4, v4, v7, vcc
    v_cndmask_b32 v5, v5, v8, vcc
    v_cvt_f32_u32 v9, v5
    v_mul_f32 v9, 0x3e800000, v9
    v_cvt_f32_u32 v230, v4
    v_mul_f32 v230, 0x3b124925, v230
    v_mul_u32_u24 v5, 4682, v4
    v_lshrrev_b32 v5, 16, v5
    v_mul_u32_u24 v5, 14, v5
    v_sub_u32 v5, v4, v5
    v_cvt_f32_u32 v232, v5
    v_mul_f32 v232, 0x3d924925, v232
    v_mul_u32_u24 v5, v2, v4
    v_mul_u32_u24 v6, 1171, v5
    v_lshrrev_b32 v6, 16, v6
    v_mul_u32_u24 v6, 56, v6
    v_sub_u32 v5, v5, v6
    v_cvt_f32_u32 v231, v5
    v_mul_f32 v231, 0x3c924925, v231
    v_cos_f32 v233, v230
    v_add_f32 v231, v231, v9
    v_add_f32 v233, v233, v233
    s_mov_b32 s32, s94
    s_mov_b32 s33, s95
    s_mov_b32 s34, s96
    s_mov_b32 s35, s97
    s_mov_b32 s36, s98
    s_mov_b32 s37, s99
    s_mov_b32 s38, s100
    s_mov_b32 s39, s101
    s_mul_i32 s6, s2, 7168
    s_lshl_b32 s7, s3, 10
    s_add_u32 s6, s6, s7
    s_add_u32 s7, s6, 4096
    buffer_load_dwordx4 a[128:131], v30, s[44:47], s6 offen
    buffer_load_dwordx4 a[132:135], v30, s[48:51], s6 offen
    buffer_load_dwordx4 a[136:139], v30, s[44:47], s7 offen
    buffer_load_dwordx4 a[140:143], v30, s[48:51], s7 offen
    s_and_b32 s6, s3, 1
    s_lshl_b32 s7, s6, 1
    s_xor_b32 s16, s7, 0
    s_xor_b32 s17, s7, 1
    s_xor_b32 s18, s7, 2
    s_xor_b32 s19, s7, 3
    s_lshr_b32 s7, s3, 1
    s_mul_i32 s7, s7, 7
    s_lshl_b32 s9, s6, 2
    s_add_u32 s9, s9, s7
    s_mov_b32 s20, s9
    s_add_u32 s21, s9, 1
    s_add_u32 s22, s9, 2
    s_add_u32 s23, s7, 3
    s_mul_i32 s7, s4, 57344
    s_lshl_b32 s8, s20, 12
    s_add_u32 s24, s7, s8
    s_lshl_b32 s90, s20, 5
    s_lshl_b32 s8, s21, 12
    s_add_u32 s25, s7, s8
    s_lshl_b32 s91, s21, 5
    s_lshl_b32 s8, s22, 12
    s_add_u32 s26, s7, s8
    s_lshl_b32 s92, s22, 5
    s_lshl_b32 s8, s23, 12
    s_add_u32 s27, s7, s8
    s_lshl_b32 s93, s23, 5
    s_cmp_eq_u32 s3, 0
    s_cselect_b32 s64, 0xffff, 0
    s_mov_b32 s65, 0
    s_mul_i32 s28, s3, 24576
    s_add_u32 s28, s28, 59392
    s_lshl_b32 s7, s5, 9
    s_lshl_b32 s9, s3, 7
    s_add_u32 s29, s7, s9
    s_mov_b32 s30, s10
    s_add_u32 s31, s10, 917504
    s_sub_u32 s8, 64, s4
    s_cmp_eq_u32 s4, 0
    s_cselect_b32 s8, 32, s8
    s_cmp_lt_u32 s3, 2
    s_cselect_b32 s8, s4, s8
    s_and_b32 s9, s3, 1
    s_lshl_b32 s9, s9, 10
    s_add_u32 s8, s8, s9
    s_mul_i32 s85, s8, 896
    s_mul_i32 s11, s4, 401408
    s_lshl_b32 s7, s3, 11
    s_add_u32 s11, s11, s7
    s_add_u32 s11, s11, 4194304
    s_lshl_b32 s13, s5, 13
    s_add_u32 s13, s13, s11
    s_add_u32 s6, s5, 1
    s_sub_u32 s7, s6, 7
    s_min_u32 s6, s6, s7
    s_mul_i32 s7, s6, 57344
    s_add_u32 s79, s13, s7
    s_add_u32 s6, s5, 2
    s_sub_u32 s7, s6, 7
    s_min_u32 s6, s6, s7
    s_mul_i32 s7, s6, 57344
    s_add_u32 s80, s13, s7
    s_add_u32 s6, s5, 3
    s_sub_u32 s7, s6, 7
    s_min_u32 s6, s6, s7
    s_mul_i32 s7, s6, 57344
    s_add_u32 s81, s13, s7
    s_add_u32 s6, s5, 4
    s_sub_u32 s7, s6, 7
    s_min_u32 s6, s6, s7
    s_mul_i32 s7, s6, 57344
    s_add_u32 s82, s13, s7
    s_add_u32 s6, s5, 5
    s_sub_u32 s7, s6, 7
    s_min_u32 s6, s6, s7
    s_mul_i32 s7, s6, 57344
    s_add_u32 s83, s13, s7
    s_add_u32 s6, s5, 6
    s_sub_u32 s7, s6, 7
    s_min_u32 s6, s6, s7
    s_mul_i32 s7, s6, 57344
    s_add_u32 s84, s13, s7
    v_cos_f32 v234, v231
    v_add_f32 v242, v231, v230
    v_cos_f32 v235, v242
    v_add_f32 v231, v231, v232
    v_fma_f32 v236, v233, v235, -v234
    v_fma_f32 v237, v233, v236, -v235
    v_cvt_pk_bf16_f32 v64, v234, v235
    v_fma_f32 v238, v233, v237, -v236
    v_fma_f32 v239, v233, v238, -v237
    v_cvt_pk_bf16_f32 v65, v236, v237
    v_fma_f32 v240, v233, v239, -v238
    v_fma_f32 v241, v233, v240, -v239
    v_cvt_pk_bf16_f32 v66, v238, v239
    v_cvt_pk_bf16_f32 v67, v240, v241
    v_cos_f32 v234, v231
    v_add_f32 v242, v231, v230
    v_cos_f32 v235, v242
    v_add_f32 v231, v231, v232
    v_mfma_f32_16x16x32_bf16 v[176:179], v[180:183], v[64:67], 0
    v_fma_f32 v236, v233, v235, -v234
    v_fma_f32 v237, v233, v236, -v235
    v_cvt_pk_bf16_f32 v68, v234, v235
    v_fma_f32 v238, v233, v237, -v236
    v_fma_f32 v239, v233, v238, -v237
    v_cvt_pk_bf16_f32 v69, v236, v237
    v_fma_f32 v240, v233, v239, -v238
    v_fma_f32 v241, v233, v240, -v239
    v_cvt_pk_bf16_f32 v70, v238, v239
    v_cvt_pk_bf16_f32 v71, v240, v241
    v_cos_f32 v234, v231
    v_add_f32 v242, v231, v230
    v_cos_f32 v235, v242
    v_add_f32 v231, v231, v232
    v_mfma_f32_16x16x32_bf16 v[176:179], v[180:183], v[68:71], v[176:179]
    v_fma_f32 v236, v233, v235, -v234
    v_fma_f32 v237, v233, v236, -v235
    v_cvt_pk_bf16_f32 v72, v234, v235
    v_fma_f32 v238, v233, v237, -v236
    v_fma_f32 v239, v233, v238, -v237
    v_cvt_pk_bf16_f32 v73, v236, v237
    v_fma_f32 v240, v233, v239, -v238
    v_fma_f32 v241, v233, v240, -v239
    v_cvt_pk_bf16_f32 v74, v238, v239
    v_cvt_pk_bf16_f32 v75, v240, v241
    v_cos_f32 v234, v231
    v_add_f32 v242, v231, v230
    v_cos_f32 v235, v242
    v_add_f32 v231, v231, v232
    v_mfma_f32_16x16x32_bf16 v[176:179], v[180:183], v[72:75], v[176:179]
    v_fma_f32 v236, v233, v235, -v234
    v_fma_f32 v237, v233, v236, -v235
    v_cvt_pk_bf16_f32 v76, v234, v235
    v_fma_f32 v238, v233, v237, -v236
    v_fma_f32 v239, v233, v238, -v237
    v_cvt_pk_bf16_f32 v77, v236, v237
    v_fma_f32 v240, v233, v239, -v238
    v_fma_f32 v241, v233, v240, -v239
    v_cvt_pk_bf16_f32 v78, v238, v239
    v_cvt_pk_bf16_f32 v79, v240, v241
    v_cos_f32 v234, v231
    v_add_f32 v242, v231, v230
    v_cos_f32 v235, v242
    v_add_f32 v231, v231, v232
    v_mfma_f32_16x16x32_bf16 v[176:179], v[180:183], v[76:79], v[176:179]
    v_fma_f32 v236, v233, v235, -v234
    v_fma_f32 v237, v233, v236, -v235
    v_cvt_pk_bf16_f32 v80, v234, v235
    v_fma_f32 v238, v233, v237, -v236
    v_fma_f32 v239, v233, v238, -v237
    v_cvt_pk_bf16_f32 v81, v236, v237
    v_fma_f32 v240, v233, v239, -v238
    v_fma_f32 v241, v233, v240, -v239
    v_cvt_pk_bf16_f32 v82, v238, v239
    v_cvt_pk_bf16_f32 v83, v240, v241
    v_cos_f32 v234, v231
    v_add_f32 v242, v231, v230
    v_cos_f32 v235, v242
    v_add_f32 v231, v231, v232
    v_mfma_f32_16x16x32_bf16 v[176:179], v[180:183], v[80:83], v[176:179]
    v_fma_f32 v236, v233, v235, -v234
    v_fma_f32 v237, v233, v236, -v235
    v_cvt_pk_bf16_f32 v84, v234, v235
    v_fma_f32 v238, v233, v237, -v236
    v_fma_f32 v239, v233, v238, -v237
    v_cvt_pk_bf16_f32 v85, v236, v237
    v_fma_f32 v240, v233, v239, -v238
    v_fma_f32 v241, v233, v240, -v239
    v_cvt_pk_bf16_f32 v86, v238, v239
    v_cvt_pk_bf16_f32 v87, v240, v241
    v_cos_f32 v234, v231
    v_add_f32 v242, v231, v230
    v_cos_f32 v235, v242
    v_add_f32 v231, v231, v232
    v_mfma_f32_16x16x32_bf16 v[176:179], v[180:183], v[84:87], v[176:179]
    v_fma_f32 v236, v233, v235, -v234
    v_fma_f32 v237, v233, v236, -v235
    v_cvt_pk_bf16_f32 v88, v234, v235
    v_fma_f32 v238, v233, v237, -v236
    v_fma_f32 v239, v233, v238, -v237
    v_cvt_pk_bf16_f32 v89, v236, v237
    v_fma_f32 v240, v233, v239, -v238
    v_fma_f32 v241, v233, v240, -v239
    v_cvt_pk_bf16_f32 v90, v238, v239
    v_cvt_pk_bf16_f32 v91, v240, v241
    v_cos_f32 v234, v231
    v_add_f32 v242, v231, v230
    v_cos_f32 v235, v242
    v_add_f32 v231, v231, v232
    v_mfma_f32_16x16x32_bf16 v[176:179], v[180:183], v[88:91], v[176:179]
    v_fma_f32 v236, v233, v235, -v234
    v_fma_f32 v237, v233, v236, -v235
    v_cvt_pk_bf16_f32 v92, v234, v235
    v_fma_f32 v238, v233, v237, -v236
    v_fma_f32 v239, v233, v238, -v237
    v_cvt_pk_bf16_f32 v93, v236, v237
    v_fma_f32 v240, v233, v239, -v238
    v_fma_f32 v241, v233, v240, -v239
    v_cvt_pk_bf16_f32 v94, v238, v239
    v_cvt_pk_bf16_f32 v95, v240, v241
    v_cos_f32 v234, v231
    v_add_f32 v242, v231, v230
    v_cos_f32 v235, v242
    v_add_f32 v231, v231, v232
    v_mfma_f32_16x16x32_bf16 v[176:179], v[180:183], v[92:95], v[176:179]
    v_fma_f32 v236, v233, v235, -v234
    v_fma_f32 v237, v233, v236, -v235
    v_cvt_pk_bf16_f32 v96, v234, v235
    v_fma_f32 v238, v233, v237, -v236
    v_fma_f32 v239, v233, v238, -v237
    v_cvt_pk_bf16_f32 v97, v236, v237
    v_fma_f32 v240, v233, v239, -v238
    v_fma_f32 v241, v233, v240, -v239
    v_cvt_pk_bf16_f32 v98, v238, v239
    v_cvt_pk_bf16_f32 v99, v240, v241
    v_cos_f32 v234, v231
    v_add_f32 v242, v231, v230
    v_cos_f32 v235, v242
    v_add_f32 v231, v231, v232
    v_mfma_f32_16x16x32_bf16 v[176:179], v[180:183], v[96:99], v[176:179]
    v_fma_f32 v236, v233, v235, -v234
    v_fma_f32 v237, v233, v236, -v235
    v_cvt_pk_bf16_f32 v100, v234, v235
    v_fma_f32 v238, v233, v237, -v236
    v_fma_f32 v239, v233, v238, -v237
    v_cvt_pk_bf16_f32 v101, v236, v237
    v_fma_f32 v240, v233, v239, -v238
    v_fma_f32 v241, v233, v240, -v239
    v_cvt_pk_bf16_f32 v102, v238, v239
    v_cvt_pk_bf16_f32 v103, v240, v241
    v_cos_f32 v234, v231
    v_add_f32 v242, v231, v230
    v_cos_f32 v235, v242
    v_add_f32 v231, v231, v232
    v_mfma_f32_16x16x32_bf16 v[176:179], v[180:183], v[100:103], v[176:179]
    v_fma_f32 v236, v233, v235, -v234
    v_fma_f32 v237, v233, v236, -v235
    v_cvt_pk_bf16_f32 v104, v234, v235
    v_fma_f32 v238, v233, v237, -v236
    v_fma_f32 v239, v233, v238, -v237
    v_cvt_pk_bf16_f32 v105, v236, v237
    v_fma_f32 v240, v233, v239, -v238
    v_fma_f32 v241, v233, v240, -v239
    v_cvt_pk_bf16_f32 v106, v238, v239
    v_cvt_pk_bf16_f32 v107, v240, v241
    s_waitcnt vmcnt(18)
    s_barrier
    s_cmp_eq_u32 s3, 0
    s_cbranch_scc0 L_arr_2
    s_and_b32 s6, s2, 3
    s_lshl_b32 s6, s6, 6
    v_mov_b32 v4, 1
    v_mov_b32 v5, 0
    s_mov_b64 exec, 1
    buffer_atomic_add v4, v5, s[60:63], s6 offen sc1
    s_mov_b64 exec, -1
L_arr_2:
    v_cos_f32 v234, v231
    v_add_f32 v242, v231, v230
    v_cos_f32 v235, v242
    v_add_f32 v231, v231, v232
    v_mfma_f32_16x16x32_bf16 v[176:179], v[180:183], v[104:107], v[176:179]
    v_fma_f32 v236, v233, v235, -v234
    v_fma_f32 v237, v233, v236, -v235
    v_cvt_pk_bf16_f32 v108, v234, v235
    v_fma_f32 v238, v233, v237, -v236
    v_fma_f32 v239, v233, v238, -v237
    v_cvt_pk_bf16_f32 v109, v236, v237
    v_fma_f32 v240, v233, v239, -v238
    v_fma_f32 v241, v233, v240, -v239
    v_cvt_pk_bf16_f32 v110, v238, v239
    v_cvt_pk_bf16_f32 v111, v240, v241
    v_cos_f32 v234, v231
    v_add_f32 v242, v231, v230
    v_cos_f32 v235, v242
    v_add_f32 v231, v231, v232
    v_mfma_f32_16x16x32_bf16 v[176:179], v[180:183], v[108:111], v[176:179]
    v_fma_f32 v236, v233, v235, -v234
    v_fma_f32 v237, v233, v236, -v235
    v_cvt_pk_bf16_f32 v112, v234, v235
    v_fma_f32 v238, v233, v237, -v236
    v_fma_f32 v239, v233, v238, -v237
    v_cvt_pk_bf16_f32 v113, v236, v237
    v_fma_f32 v240, v233, v239, -v238
    v_fma_f32 v241, v233, v240, -v239
    v_cvt_pk_bf16_f32 v114, v238, v239
    v_cvt_pk_bf16_f32 v115, v240, v241
    v_cos_f32 v234, v231
    v_add_f32 v242, v231, v230
    v_cos_f32 v235, v242
    s_nop 0
    v_mfma_f32_16x16x32_bf16 v[176:179], v[180:183], v[112:115], v[176:179]
    v_fma_f32 v236, v233, v235, -v234
    v_fma_f32 v237, v233, v236, -v235
    v_cvt_pk_bf16_f32 v116, v234, v235
    v_fma_f32 v238, v233, v237, -v236
    v_fma_f32 v239, v233, v238, -v237
    v_cvt_pk_bf16_f32 v117, v236, v237
    v_fma_f32 v240, v233, v239, -v238
    v_fma_f32 v241, v233, v240, -v239
    v_cvt_pk_bf16_f32 v118, v238, v239
    v_cvt_pk_bf16_f32 v119, v240, v241
    s_nop 0
    s_nop 0
    v_mfma_f32_16x16x32_bf16 v[176:179], v[180:183], v[116:119], v[176:179]
    s_lshl_b32 s6, s3, 4
    v_lshl_add_u32 v4, v2, 2, s6
    v_cvt_f32_u32 v4, v4
    v_mul_f32 v230, 0x3c800000, v4
    v_add_f32 v231, 0x3c800000, v230
    v_add_f32 v232, 0x3c800000, v231
    v_add_f32 v233, 0x3c800000, v232
    s_lshl_b32 s6, s3, 9
    s_add_u32 s6, s6, 59392
    v_lshl_add_u32 v250, v0, 3, s6
    v_cvt_f32_u32 v234, v1
    v_mov_b32 v5, 0xbc003c00
    v_cmp_eq_u32 vcc, 0, v1
    v_mul_f32 v235, v234, v230
    v_cos_f32 v238, v235
    v_sin_f32 v242, -v235
    v_mul_f32 v236, v234, v231
    v_cos_f32 v239, v236
    v_sin_f32 v243, -v236
    v_mul_f32 v235, v234, v232
    v_cos_f32 v240, v235
    v_sin_f32 v244, -v235
    v_mul_f32 v236, v234, v233
    v_cos_f32 v241, v236
    v_sin_f32 v245, -v236
    v_cvt_pk_f16_f32 v246, v238, v239
    v_cvt_pk_f16_f32 v247, v240, v241
    v_cvt_pk_f16_f32 v248, v242, v243
    v_cvt_pk_f16_f32 v249, v244, v245
    v_cndmask_b32 v248, v248, v5, vcc
    v_cndmask_b32 v249, v249, v5, vcc
    ds_write_b64 v250, v[246:247] offset:0
    ds_write_b64 v250, v[248:249] offset:2048
    v_add_f32 v234, 0x41800000, v234
    v_mul_f32 v235, v234, v230
    v_cos_f32 v238, v235
    v_sin_f32 v242, -v235
    v_mul_f32 v236, v234, v231
    v_cos_f32 v239, v236
    v_sin_f32 v243, -v236
    v_mul_f32 v235, v234, v232
    v_cos_f32 v240, v235
    v_sin_f32 v244, -v235
    v_mul_f32 v236, v234, v233
    v_cos_f32 v241, v236
    v_sin_f32 v245, -v236
    v_cvt_pk_f16_f32 v246, v238, v239
    v_cvt_pk_f16_f32 v247, v240, v241
    v_cvt_pk_f16_f32 v248, v242, v243
    v_cvt_pk_f16_f32 v249, v244, v245
    ds_write_b64 v250, v[246:247] offset:4096
    ds_write_b64 v250, v[248:249] offset:6144
    s_sub_u32 s8, 64, s4
    s_cmp_eq_u32 s4, 0
    s_cselect_b32 s8, 32, s8
    s_cmp_lt_u32 s3, 2
    s_cselect_b32 s8, s4, s8
    s_and_b32 s9, s3, 1
    s_lshl_b32 s9, s9, 10
    s_add_u32 s8, s8, s9
    v_lshl_add_u32 v4, v1, 6, s8
    v_cvt_f32_u32 v231, v4
    v_mul_f32 v231, 0x3a000000, v231
    s_cmp_lt_u32 s3, 2
    s_mov_b32 s9, 0x3020100
    s_mov_b32 s12, 0x3020100
    s_cselect_b32 s9, s9, s12
    s_mov_b32 s13, 0xc0c0100
    s_mov_b32 s12, 0x1000c0c
    s_cselect_b32 s13, s13, s12
    s_cmp_eq_u32 s4, 0
    s_cselect_b32 s94, s13, s9
    s_cmp_lt_u32 s3, 2
    s_mov_b32 s9, 0x1000302
    s_mov_b32 s12, 0x1000302
    s_cselect_b32 s9, s9, s12
    s_mov_b32 s13, 0xc0c0302
    s_mov_b32 s12, 0x3020c0c
    s_cselect_b32 s13, s13, s12
    s_cmp_eq_u32 s4, 0
    s_cselect_b32 s95, s13, s9
    s_cmp_lt_u32 s3, 2
    s_mov_b32 s9, 0x80000000
    s_mov_b32 s12, 0x8000
    s_cselect_b32 s9, s9, s12
    s_mov_b32 s13, 0x0
    s_mov_b32 s12, 0x0
    s_cselect_b32 s13, s13, s12
    s_cmp_eq_u32 s4, 0
    s_cselect_b32 s96, s13, s9
    s_cmp_lt_u32 s3, 2
    s_mov_b32 s9, 0x0
    s_mov_b32 s12, 0x80000000
    s_cselect_b32 s9, s9, s12
    s_mov_b32 s13, 0x0
    s_mov_b32 s12, 0x0
    s_cselect_b32 s13, s13, s12
    s_cmp_eq_u32 s4, 0
    s_cselect_b32 s97, s13, s9
    v_xor_b32 v231, s97, v231
    s_lshl_b32 s6, s3, 12
    s_add_u32 s6, s6, 67584
    v_add_u32 v246, s6, v30
    v_lshlrev_b32 v4, 2, v2
    v_cvt_f32_u32 v4, v4
    v_mul_f32 v230, v4, v231
    v_cos_f32 v232, v230
    v_sin_f32 v233, v230
    v_add_f32 v230, v230, v231
    v_cvt_pk_f16_f32 v234, v232, v233
    v_perm_b32 v238, v234, v234, s94
    v_perm_b32 v242, v234, v234, s95
    v_xor_b32 v242, s96, v242
    v_cos_f32 v232, v230
    v_sin_f32 v233, v230
    v_add_f32 v230, v230, v231
    v_cvt_pk_f16_f32 v234, v232, v233
    v_perm_b32 v239, v234, v234, s94
    v_perm_b32 v243, v234, v234, s95
    v_xor_b32 v243, s96, v243
    v_cos_f32 v232, v230
    v_sin_f32 v233, v230
    v_add_f32 v230, v230, v231
    v_cvt_pk_f16_f32 v234, v232, v233
    v_perm_b32 v240, v234, v234, s94
    v_perm_b32 v244, v234, v234, s95
    v_xor_b32 v244, s96, v244
    v_cos_f32 v232, v230
    v_sin_f32 v233, v230
    v_add_f32 v230, v230, v231
    v_cvt_pk_f16_f32 v234, v232, v233
    v_perm_b32 v241, v234, v234, s94
    v_perm_b32 v245, v234, v234, s95
    v_xor_b32 v245, s96, v245
    ds_write_b128 v246, v[238:241] offset:0
    ds_write_b128 v246, v[242:245] offset:1024
    v_add_f32 v4, 0x41800000, v4
    v_mul_f32 v230, v4, v231
    v_cos_f32 v232, v230
    v_sin_f32 v233, v230
    v_add_f32 v230, v230, v231
    v_cvt_pk_f16_f32 v234, v232, v233
    v_perm_b32 v238, v234, v234, s94
    v_perm_b32 v242, v234, v234, s95
    v_xor_b32 v242, s96, v242
    v_cos_f32 v232, v230
    v_sin_f32 v233, v230
    v_add_f32 v230, v230, v231
    v_cvt_pk_f16_f32 v234, v232, v233
    v_perm_b32 v239, v234, v234, s94
    v_perm_b32 v243, v234, v234, s95
    v_xor_b32 v243, s96, v243
    v_cos_f32 v232, v230
    v_sin_f32 v233, v230
    v_add_f32 v230, v230, v231
    v_cvt_pk_f16_f32 v234, v232, v233
    v_perm_b32 v240, v234, v234, s94
    v_perm_b32 v244, v234, v234, s95
    v_xor_b32 v244, s96, v244
    v_cos_f32 v232, v230
    v_sin_f32 v233, v230
    v_add_f32 v230, v230, v231
    v_cvt_pk_f16_f32 v234, v232, v233
    v_perm_b32 v241, v234, v234, s94
    v_perm_b32 v245, v234, v234, s95
    v_xor_b32 v245, s96, v245
    ds_write_b128 v246, v[238:241] offset:2048
    ds_write_b128 v246, v[242:245] offset:3072
    s_lshl_b32 s6, s3, 9
    s_add_u32 s6, s6, 59392
    v_lshl_add_u32 v230, v0, 3, s6
    s_add_u32 s6, s3, 1
    s_and_b32 s6, s6, 3
    s_lshl_b32 s6, s6, 9
    s_add_u32 s6, s6, 59392
    v_lshl_add_u32 v231, v0, 3, s6
    s_add_u32 s6, s3, 2
    s_and_b32 s6, s6, 3
    s_lshl_b32 s6, s6, 9
    s_add_u32 s6, s6, 59392
    v_lshl_add_u32 v232, v0, 3, s6
    s_add_u32 s6, s3, 3
    s_and_b32 s6, s6, 3
    s_lshl_b32 s6, s6, 9
    s_add_u32 s6, s6, 59392
    v_lshl_add_u32 v233, v0, 3, s6
    s_lshl_b32 s6, s16, 12
    s_add_u32 s6, s6, 67584
    v_add_u32 v234, s6, v30
    s_lshl_b32 s6, s17, 12
    s_add_u32 s6, s6, 67584
    v_add_u32 v235, s6, v30
    s_lshl_b32 s6, s18, 12
    s_add_u32 s6, s6, 67584
    v_add_u32 v236, s6, v30
    s_lshl_b32 s6, s19, 12
    s_add_u32 s6, s6, 67584
    v_add_u32 v237, s6, v30
    s_waitcnt vmcnt(4)
    s_waitcnt lgkmcnt(0)
    s_barrier
    ds_read_b128 v[120:123], v216 offset:0
    ds_read_b128 v[124:127], v218 offset:0
    ds_read_b128 v[128:131], v220 offset:0
    ds_read_b128 v[132:135], v222 offset:0
    ds_read_b128 v[136:139], v217 offset:0
    ds_read_b128 v[140:143], v219 offset:0
    ds_read_b128 v[144:147], v221 offset:0
    ds_read_b128 v[148:151], v223 offset:0
    s_waitcnt lgkmcnt(4)
    v_mfma_f32_16x16x32_bf16 v[172:175], v[120:123], v[120:123], 0
    ds_read_b128 v[238:241], v216 offset:8192
    v_mfma_f32_16x16x32_bf16 v[168:171], v[180:183], v[120:123], 0
    ds_read_b128 v[242:245], v218 offset:8192
    v_mfma_f32_16x16x32_bf16 v[152:155], v[120:123], v[64:67], 0
    ds_read_b128 v[246:249], v220 offset:8192
    v_mfma_f32_16x16x32_bf16 v[156:159], v[124:127], v[64:67], 0
    ds_read_b128 v[250:253], v222 offset:8192
    v_mfma_f32_16x16x32_bf16 v[160:163], v[128:131], v[64:67], 0
    ds_read_b64 v[184:185], v230 offset:0
    v_mfma_f32_16x16x32_bf16 v[164:167], v[132:135], v[64:67], 0
    ds_read_b64 v[192:193], v230 offset:2048
    s_waitcnt lgkmcnt(6)
    v_mfma_f32_16x16x32_bf16 v[172:175], v[136:139], v[136:139], v[172:175]
    ds_read_b128 v[120:123], v217 offset:8192
    v_mfma_f32_16x16x32_bf16 v[168:171], v[180:183], v[136:139], v[168:171]
    ds_read_b128 v[124:127], v219 offset:8192
    v_mfma_f32_16x16x32_bf16 v[152:155], v[136:139], v[68:71], v[152:155]
    ds_read_b128 v[128:131], v221 offset:8192
    v_mfma_f32_16x16x32_bf16 v[156:159], v[140:143], v[68:71], v[156:159]
    ds_read_b128 v[132:135], v223 offset:8192
    v_mfma_f32_16x16x32_bf16 v[160:163], v[144:147], v[68:71], v[160:163]
    ds_read_b64 v[200:201], v230 offset:4096
    v_mfma_f32_16x16x32_bf16 v[164:167], v[148:151], v[68:71], v[164:167]
    ds_read_b64 v[208:209], v230 offset:6144
    s_waitcnt lgkmcnt(8)
    v_mfma_f32_16x16x32_bf16 v[172:175], v[238:241], v[238:241], v[172:175]
    ds_read_b128 v[136:139], v216 offset:16384
    v_mfma_f32_16x16x32_bf16 v[168:171], v[180:183], v[238:241], v[168:171]
    ds_read_b128 v[140:143], v218 offset:16384
    v_mfma_f32_16x16x32_bf16 v[152:155], v[238:241], v[72:75], v[152:155]
    ds_read_b128 v[144:147], v220 offset:16384
    v_mfma_f32_16x16x32_bf16 v[156:159], v[242:245], v[72:75], v[156:159]
    ds_read_b128 v[148:151], v222 offset:16384
    v_mfma_f32_16x16x32_bf16 v[160:163], v[246:249], v[72:75], v[160:163]
    ds_read_b64 v[186:187], v231 offset:0
    v_mfma_f32_16x16x32_bf16 v[164:167], v[250:253], v[72:75], v[164:167]
    ds_read_b64 v[194:195], v231 offset:2048
    s_waitcnt lgkmcnt(8)
    v_mfma_f32_16x16x32_bf16 v[172:175], v[120:123], v[120:123], v[172:175]
    ds_read_b128 v[238:241], v217 offset:16384
    v_mfma_f32_16x16x32_bf16 v[168:171], v[180:183], v[120:123], v[168:171]
    ds_read_b128 v[242:245], v219 offset:16384
    v_mfma_f32_16x16x32_bf16 v[152:155], v[120:123], v[76:79], v[152:155]
    ds_read_b128 v[246:249], v221 offset:16384
    v_mfma_f32_16x16x32_bf16 v[156:159], v[124:127], v[76:79], v[156:159]
    ds_read_b128 v[250:253], v223 offset:16384
    v_mfma_f32_16x16x32_bf16 v[160:163], v[128:131], v[76:79], v[160:163]
    ds_read_b64 v[202:203], v231 offset:4096
    v_mfma_f32_16x16x32_bf16 v[164:167], v[132:135], v[76:79], v[164:167]
    ds_read_b64 v[210:211], v231 offset:6144
    s_waitcnt lgkmcnt(8)
    v_mfma_f32_16x16x32_bf16 v[172:175], v[136:139], v[136:139], v[172:175]
    ds_read_b128 v[120:123], v216 offset:24576
    v_mfma_f32_16x16x32_bf16 v[168:171], v[180:183], v[136:139], v[168:171]
    ds_read_b128 v[124:127], v218 offset:24576
    v_mfma_f32_16x16x32_bf16 v[152:155], v[136:139], v[80:83], v[152:155]
    ds_read_b128 v[128:131], v220 offset:24576
    v_mfma_f32_16x16x32_bf16 v[156:159], v[140:143], v[80:83], v[156:159]
    ds_read_b128 v[132:135], v222 offset:24576
    v_mfma_f32_16x16x32_bf16 v[160:163], v[144:147], v[80:83], v[160:163]
    ds_read_b64 v[188:189], v232 offset:0
    v_mfma_f32_16x16x32_bf16 v[164:167], v[148:151], v[80:83], v[164:167]
    ds_read_b64 v[196:197], v232 offset:2048
    s_waitcnt lgkmcnt(8)
    v_mfma_f32_16x16x32_bf16 v[172:175], v[238:241], v[238:241], v[172:175]
    ds_read_b128 v[136:139], v217 offset:24576
    v_mfma_f32_16x16x32_bf16 v[168:171], v[180:183], v[238:241], v[168:171]
    ds_read_b128 v[140:143], v219 offset:24576
    v_mfma_f32_16x16x32_bf16 v[152:155], v[238:241], v[84:87], v[152:155]
    ds_read_b128 v[144:147], v221 offset:24576
    v_mfma_f32_16x16x32_bf16 v[156:159], v[242:245], v[84:87], v[156:159]
    ds_read_b128 v[148:151], v223 offset:24576
    v_mfma_f32_16x16x32_bf16 v[160:163], v[246:249], v[84:87], v[160:163]
    ds_read_b64 v[204:205], v232 offset:4096
    v_mfma_f32_16x16x32_bf16 v[164:167], v[250:253], v[84:87], v[164:167]
    ds_read_b64 v[212:213], v232 offset:6144
    s_waitcnt lgkmcnt(8)
    v_mfma_f32_16x16x32_bf16 v[172:175], v[120:123], v[120:123], v[172:175]
    ds_read_b128 v[238:241], v216 offset:32768
    v_mfma_f32_16x16x32_bf16 v[168:171], v[180:183], v[120:123], v[168:171]
    ds_read_b128 v[242:245], v218 offset:32768
    v_mfma_f32_16x16x32_bf16 v[152:155], v[120:123], v[88:91], v[152:155]
    ds_read_b128 v[246:249], v220 offset:32768
    v_mfma_f32_16x16x32_bf16 v[156:159], v[124:127], v[88:91], v[156:159]
    ds_read_b128 v[250:253], v222 offset:32768
    v_mfma_f32_16x16x32_bf16 v[160:163], v[128:131], v[88:91], v[160:163]
    ds_read_b64 v[190:191], v233 offset:0
    v_mfma_f32_16x16x32_bf16 v[164:167], v[132:135], v[88:91], v[164:167]
    ds_read_b64 v[198:199], v233 offset:2048
    s_waitcnt lgkmcnt(8)
    v_mfma_f32_16x16x32_bf16 v[172:175], v[136:139], v[136:139], v[172:175]
    ds_read_b128 v[120:123], v217 offset:32768
    v_mfma_f32_16x16x32_bf16 v[168:171], v[180:183], v[136:139], v[168:171]
    ds_read_b128 v[124:127], v219 offset:32768
    v_mfma_f32_16x16x32_bf16 v[152:155], v[136:139], v[92:95], v[152:155]
    ds_read_b128 v[128:131], v221 offset:32768
    v_mfma_f32_16x16x32_bf16 v[156:159], v[140:143], v[92:95], v[156:159]
    ds_read_b128 v[132:135], v223 offset:32768
    v_mfma_f32_16x16x32_bf16 v[160:163], v[144:147], v[92:95], v[160:163]
    ds_read_b64 v[206:207], v233 offset:4096
    v_mfma_f32_16x16x32_bf16 v[164:167], v[148:151], v[92:95], v[164:167]
    ds_read_b64 v[214:215], v233 offset:6144
    s_waitcnt lgkmcnt(8)
    v_mfma_f32_16x16x32_bf16 v[172:175], v[238:241], v[238:241], v[172:175]
    ds_read_b128 v[136:139], v216 offset:40960
    v_mfma_f32_16x16x32_bf16 v[168:171], v[180:183], v[238:241], v[168:171]
    ds_read_b128 v[140:143], v218 offset:40960
    v_mfma_f32_16x16x32_bf16 v[152:155], v[238:241], v[96:99], v[152:155]
    v_mfma_f32_16x16x32_bf16 v[156:159], v[242:245], v[96:99], v[156:159]
    ds_read_b128 v[144:147], v220 offset:40960
    v_mfma_f32_16x16x32_bf16 v[160:163], v[246:249], v[96:99], v[160:163]
    ds_read_b128 v[148:151], v222 offset:40960
    v_mfma_f32_16x16x32_bf16 v[164:167], v[250:253], v[96:99], v[164:167]
    s_waitcnt lgkmcnt(6)
    v_mfma_f32_16x16x32_bf16 v[172:175], v[120:123], v[120:123], v[172:175]
    ds_read_b128 v[238:241], v217 offset:40960
    v_mfma_f32_16x16x32_bf16 v[168:171], v[180:183], v[120:123], v[168:171]
    ds_read_b128 v[242:245], v219 offset:40960
    v_mfma_f32_16x16x32_bf16 v[152:155], v[120:123], v[100:103], v[152:155]
    v_mfma_f32_16x16x32_bf16 v[156:159], v[124:127], v[100:103], v[156:159]
    ds_read_b128 v[246:249], v221 offset:40960
    v_mfma_f32_16x16x32_bf16 v[160:163], v[128:131], v[100:103], v[160:163]
    ds_read_b128 v[250:253], v223 offset:40960
    v_mfma_f32_16x16x32_bf16 v[164:167], v[132:135], v[100:103], v[164:167]
    s_waitcnt lgkmcnt(4)
    v_mfma_f32_16x16x32_bf16 v[172:175], v[136:139], v[136:139], v[172:175]
    ds_read_b128 v[120:123], v216 offset:49152
    v_mfma_f32_16x16x32_bf16 v[168:171], v[180:183], v[136:139], v[168:171]
    ds_read_b128 v[124:127], v218 offset:49152
    v_mfma_f32_16x16x32_bf16 v[152:155], v[136:139], v[104:107], v[152:155]
    v_mfma_f32_16x16x32_bf16 v[156:159], v[140:143], v[104:107], v[156:159]
    ds_read_b128 v[128:131], v220 offset:49152
    v_mfma_f32_16x16x32_bf16 v[160:163], v[144:147], v[104:107], v[160:163]
    ds_read_b128 v[132:135], v222 offset:49152
    v_mfma_f32_16x16x32_bf16 v[164:167], v[148:151], v[104:107], v[164:167]
    s_waitcnt lgkmcnt(4)
    v_mfma_f32_16x16x32_bf16 v[172:175], v[238:241], v[238:241], v[172:175]
    ds_read_b128 v[136:139], v217 offset:49152
    v_mfma_f32_16x16x32_bf16 v[168:171], v[180:183], v[238:241], v[168:171]
    ds_read_b128 v[140:143], v219 offset:49152
    v_mfma_f32_16x16x32_bf16 v[152:155], v[238:241], v[108:111], v[152:155]
    v_mfma_f32_16x16x32_bf16 v[156:159], v[242:245], v[108:111], v[156:159]
    ds_read_b128 v[144:147], v221 offset:49152
    v_mfma_f32_16x16x32_bf16 v[160:163], v[246:249], v[108:111], v[160:163]
    ds_read_b128 v[148:151], v223 offset:49152
    v_mfma_f32_16x16x32_bf16 v[164:167], v[250:253], v[108:111], v[164:167]
    s_waitcnt lgkmcnt(4)
    v_mfma_f32_16x16x32_bf16 v[172:175], v[120:123], v[120:123], v[172:175]
    v_mfma_f32_16x16x32_bf16 v[168:171], v[180:183], v[120:123], v[168:171]
    v_mfma_f32_16x16x32_bf16 v[152:155], v[120:123], v[112:115], v[152:155]
    v_mfma_f32_16x16x32_bf16 v[156:159], v[124:127], v[112:115], v[156:159]
    v_mfma_f32_16x16x32_bf16 v[160:163], v[128:131], v[112:115], v[160:163]
    v_mfma_f32_16x16x32_bf16 v[164:167], v[132:135], v[112:115], v[164:167]
    s_waitcnt lgkmcnt(0)
    v_mfma_f32_16x16x32_bf16 v[172:175], v[136:139], v[136:139], v[172:175]
    v_mfma_f32_16x16x32_bf16 v[168:171], v[180:183], v[136:139], v[168:171]
    v_mfma_f32_16x16x32_bf16 v[152:155], v[136:139], v[116:119], v[152:155]
    v_mfma_f32_16x16x32_bf16 v[156:159], v[140:143], v[116:119], v[156:159]
    v_mfma_f32_16x16x32_bf16 v[160:163], v[144:147], v[116:119], v[160:163]
    v_mfma_f32_16x16x32_bf16 v[164:167], v[148:151], v[116:119], v[164:167]
    s_nop 2
    v_cndmask_b32 v172, v172, v173, s[34:35]
    v_mul_f32 v168, 0x3b124925, v168
    v_cndmask_b32 v172, v172, v174, s[36:37]
    v_cndmask_b32 v172, v172, v175, s[38:39]
    v_mul_f32 v172, 0x3b124925, v172
    v_fma_f32 v172, -v168, v168, v172
    v_max_f32 v172, 0, v172
    v_add_f32 v172, 0x3727c5ac, v172
    v_rsq_f32 v172, v172
    s_lshl_b32 s6, s3, 6
    s_add_u32 s6, s6, 157696
    v_lshl_add_u32 v4, v1, 2, s6
    v_mul_f32 v168, v172, v168
    v_add_f32 v172, v172, v172
    v_mul_f32 v168, -2.0, v168
    s_mov_b64 exec, s[32:33]
    ds_write_b32 v4, v172
    ds_write_b32 v4, v168 offset:256
    s_mov_b64 exec, -1
    s_waitcnt lgkmcnt(0)
    s_barrier
    ds_read_b128 v[120:123], v224
    ds_read_b128 v[124:127], v224 offset:256
    ds_read_b128 v[128:131], v225
    ds_read_b128 v[132:135], v225 offset:256
    ds_read_b128 v[136:139], v226
    ds_read_b128 v[140:143], v226 offset:256
    ds_read_b128 v[144:147], v227
    ds_read_b128 v[148:151], v227 offset:256
    s_waitcnt lgkmcnt(6)
    v_pk_mul_f32 v[124:125], v[124:125], v[176:177] op_sel_hi:[1,0]
    v_pk_mul_f32 v[126:127], v[126:127], v[176:177] op_sel_hi:[1,0]
    v_pk_fma_f32 v[152:153], v[120:121], v[152:153], v[124:125]
    v_pk_fma_f32 v[154:155], v[122:123], v[154:155], v[126:127]
    v_cvt_pk_f16_f32 v64, v152, v153
    v_cvt_pk_f16_f32 v65, v154, v155
    s_waitcnt lgkmcnt(4)
    v_pk_mul_f32 v[132:133], v[132:133], v[176:177] op_sel_hi:[1,0]
    v_pk_mul_f32 v[134:135], v[134:135], v[176:177] op_sel_hi:[1,0]
    v_pk_fma_f32 v[156:157], v[128:129], v[156:157], v[132:133]
    v_pk_fma_f32 v[158:159], v[130:131], v[158:159], v[134:135]
    v_cvt_pk_f16_f32 v66, v156, v157
    v_cvt_pk_f16_f32 v67, v158, v159
    s_waitcnt lgkmcnt(2)
    v_pk_mul_f32 v[140:141], v[140:141], v[176:177] op_sel_hi:[1,0]
    v_pk_mul_f32 v[142:143], v[142:143], v[176:177] op_sel_hi:[1,0]
    v_pk_fma_f32 v[160:161], v[136:137], v[160:161], v[140:141]
    v_pk_fma_f32 v[162:163], v[138:139], v[162:163], v[142:143]
    v_cvt_pk_f16_f32 v68, v160, v161
    v_cvt_pk_f16_f32 v69, v162, v163
    s_waitcnt lgkmcnt(0)
    v_pk_mul_f32 v[148:149], v[148:149], v[176:177] op_sel_hi:[1,0]
    v_pk_mul_f32 v[150:151], v[150:151], v[176:177] op_sel_hi:[1,0]
    v_pk_fma_f32 v[164:165], v[144:145], v[164:165], v[148:149]
    v_pk_fma_f32 v[166:167], v[146:147], v[166:167], v[150:151]
    v_cvt_pk_f16_f32 v70, v164, v165
    v_cvt_pk_f16_f32 v71, v166, v167
    v_mfma_f32_16x16x32_f16 v[72:75], v[64:67], v[184:187], 0
    v_mfma_f32_16x16x32_f16 v[76:79], v[64:67], v[192:195], 0
    v_mfma_f32_16x16x32_f16 v[80:83], v[64:67], v[200:203], 0
    v_mfma_f32_16x16x32_f16 v[84:87], v[64:67], v[208:211], 0
    v_mfma_f32_16x16x32_f16 v[72:75], v[68:71], v[188:191], v[72:75]
    v_mfma_f32_16x16x32_f16 v[76:79], v[68:71], v[196:199], v[76:79]
    v_mfma_f32_16x16x32_f16 v[80:83], v[68:71], v[204:207], v[80:83]
    v_mfma_f32_16x16x32_f16 v[84:87], v[68:71], v[212:215], v[84:87]
    s_nop 5
    v_cvt_pk_f16_f32 v88, v72, v76
    v_cvt_pk_f16_f32 v89, v73, v77
    v_cvt_pk_f16_f32 v90, v74, v78
    v_cvt_pk_f16_f32 v91, v75, v79
    buffer_store_dwordx4 v[88:91], v229, s[52:55], s30 offen sc1
    v_cvt_pk_f16_f32 v92, v80, v84
    v_cvt_pk_f16_f32 v93, v81, v85
    v_cvt_pk_f16_f32 v94, v82, v86
    v_cvt_pk_f16_f32 v95, v83, v87
    buffer_store_dwordx4 v[92:95], v229, s[52:55], s31 offen sc1
    v_and_b32 v254, 3, v0
    v_lshlrev_b32 v254, 6, v254
    buffer_load_dword v254, v254, s[60:63], 0 offen sc1
    s_mul_i32 s96, s3, 14848
    v_lshrrev_b32 v4, 1, v0
    v_mul_u32_u24 v4, 928, v4
    v_and_b32 v5, 1, v0
    v_lshl_add_u32 v4, v5, 4, v4
    v_add_u32 v4, s96, v4
    v_mov_b32 v8, 0
    v_mov_b32 v9, 0
    v_mov_b32 v10, 0
    v_mov_b32 v11, 0
    s_mov_b32 exec_hi, 0
    ds_write_b128 v4, v[8:11] offset:896
    s_mov_b32 exec_hi, -1
    s_sub_u32 s98, 864, s90
    s_sub_u32 s99, 864, s91
    s_sub_u32 s100, 864, s92
    s_add_u32 m0, s96, 0
    s_add_u32 s95, s85, 0
    s_mov_b32 exec_hi, 0x00ffffff
    buffer_load_dwordx4 v30, s[40:43], s95 offen lds
    s_mov_b32 exec_hi, -1
    s_sub_u32 s101, 864, s93
    ds_read_b128 a[0:3], v234 offset:0
    v_lshlrev_b32 v4, 3, v1
    v_lshl_add_u32 v31, v2, 9, v4
    s_lshl_b32 s7, s20, 12
    s_lshl_b32 s8, s23, 12
    s_lshl_b32 s6, s16, 10
    s_add_u32 s9, s6, s7
    v_add_u32 v32, s9, v30
    s_add_u32 m0, s96, 928
    s_add_u32 s95, s85, 57344
    s_mov_b32 exec_hi, 0x00ffffff
    buffer_load_dwordx4 v30, s[40:43], s95 offen lds
    s_mov_b32 exec_hi, -1
    s_add_u32 s9, s6, s8
    ds_read_b128 a[4:7], v234 offset:1024
    v_add_u32 v36, s9, v30
    s_lshl_b32 s6, s3, 10
    v_add_u32 v12, s6, v30
    s_lshl_b32 s6, s17, 10
    s_add_u32 s9, s6, s7
    v_add_u32 v33, s9, v30
    s_add_u32 m0, s96, 1856
    s_add_u32 s95, s85, 114688
    s_mov_b32 exec_hi, 0x00ffffff
    buffer_load_dwordx4 v30, s[40:43], s95 offen lds
    s_mov_b32 exec_hi, -1
    s_add_u32 s9, s6, s8
    v_add_u32 v37, s9, v30
    s_add_u32 s6, s3, 1
    ds_read_b128 a[8:11], v234 offset:2048
    s_and_b32 s6, s6, 3
    s_lshl_b32 s6, s6, 10
    v_add_u32 v13, s6, v30
    s_lshl_b32 s6, s18, 10
    s_add_u32 s9, s6, s7
    s_add_u32 m0, s96, 2784
    s_add_u32 s95, s85, 172032
    s_mov_b32 exec_hi, 0x00ffffff
    buffer_load_dwordx4 v30, s[40:43], s95 offen lds
    s_mov_b32 exec_hi, -1
    v_add_u32 v34, s9, v30
    s_add_u32 s6, s3, 2
    s_and_b32 s6, s6, 3
    ds_read_b128 a[12:15], v234 offset:3072
    s_lshl_b32 s6, s6, 10
    v_add_u32 v14, s6, v30
    s_lshl_b32 s6, s19, 10
    s_add_u32 s9, s6, s7
    s_add_u32 m0, s96, 3712
    s_add_u32 s95, s85, 229376
    s_mov_b32 exec_hi, 0x00ffffff
    buffer_load_dwordx4 v30, s[40:43], s95 offen lds
    s_mov_b32 exec_hi, -1
    v_add_u32 v35, s9, v30
    s_add_u32 s6, s3, 3
    s_and_b32 s6, s6, 3
    s_lshl_b32 s6, s6, 10
    ds_read_b128 a[16:19], v235 offset:0
    v_add_u32 v15, s6, v30
    v_lshrrev_b32 v4, 2, v1
    v_lshl_add_u32 v4, v2, 2, v4
    v_bfe_u32 v5, v4, 1, 2
    s_add_u32 m0, s96, 4640
    s_add_u32 s95, s85, 286720
    s_mov_b32 exec_hi, 0x00ffffff
    buffer_load_dwordx4 v30, s[40:43], s95 offen lds
    s_mov_b32 exec_hi, -1
    v_and_b32 v6, 3, v0
    v_lshlrev_b32 v6, 3, v6
    v_lshl_add_u32 v6, v4, 7, v6
    v_add_u32 v8, s28, v6
    v_xor_b32 v7, 0, v5
    ds_read_b128 a[20:23], v235 offset:1024
    v_lshl_add_u32 v16, v7, 5, v8
    v_xor_b32 v7, 1, v5
    s_add_u32 m0, s96, 5568
    s_add_u32 s95, s85, 344064
    s_mov_b32 exec_hi, 0x00ffffff
    buffer_load_dwordx4 v30, s[40:43], s95 offen lds
    s_mov_b32 exec_hi, -1
    v_lshl_add_u32 v17, v7, 5, v8
    v_xor_b32 v7, 2, v5
    v_lshl_add_u32 v18, v7, 5, v8
    v_xor_b32 v7, 3, v5
    v_lshl_add_u32 v19, v7, 5, v8
    v_xor_b32 v7, s3, v5
    ds_read_b128 a[24:27], v235 offset:2048
    v_lshl_add_u32 v7, v7, 5, v6
    v_add_u32 v28, 59392, v7
    s_add_u32 m0, s96, 6496
    s_add_u32 s95, s85, 401408
    s_mov_b32 exec_hi, 0x00ffffff
    buffer_load_dwordx4 v30, s[40:43], s95 offen lds
    s_mov_b32 exec_hi, -1
    v_add_u32 v29, 108544, v7
    v_mov_b32 v59, v7
    v_lshrrev_b32 v4, 3, v0
    v_bfe_u32 v5, v4, 1, 2
    v_lshlrev_b32 v5, 1, v5
    v_and_b32 v6, 7, v0
    v_xor_b32 v6, v6, v5
    buffer_store_dwordx4 v[60:63], v30, s[52:55], s79 offen offset:0 sc1
    ds_read_b128 a[28:31], v235 offset:3072
    v_lshlrev_b32 v6, 4, v6
    v_mul_u32_u24 v5, 3584, v4
    v_add_u32 v20, v5, v6
    v_add_u32 v21, 27648, v20
    v_sub_u32 v7, v6, v5
    v_add_u32 v22, 55808, v7
    v_add_u32 v23, 26112, v7
    v_sub_u32 v7, 448, v4
    s_add_u32 m0, s96, 7424
    s_add_u32 s95, s85, 458752
    s_mov_b32 exec_hi, 0x00ffffff
    buffer_load_dwordx4 v30, s[40:43], s95 offen lds
    s_mov_b32 exec_hi, -1
    ds_read_b128 a[32:35], v236 offset:0
    v_mov_b32 v8, 224
    v_cmp_eq_u32 vcc, 0, v4
    v_mul_u32_u24 v5, 896, v4
    s_nop 0
    v_cndmask_b32 v7, v7, v8, vcc
    v_mul_u32_u24 v7, 3584, v7
    v_add_u32 v7, v7, v6
    v_subrev_u32 v3, 2048, v7
    s_add_u32 m0, s96, 8352
    s_add_u32 s95, s85, 516096
    s_mov_b32 exec_hi, 0x00ffffff
    buffer_load_dwordx4 v30, s[40:43], s95 offen lds
    s_mov_b32 exec_hi, -1
    v_add_u32 v24, v5, v6
    v_add_u32 v25, 6144, v24
    ds_read_b128 a[36:39], v236 offset:1024
    v_add_u32 v26, 12288, v24
    v_add_u32 v27, 18432, v24
    v_mul_u32_u24 v4, 928, v1
    v_lshl_add_u32 v4, v2, 4, v4
    s_mul_i32 s6, s16, 14848
    v_add_u32 v54, s6, v4
    s_add_u32 m0, s96, 9280
    s_add_u32 s95, s85, 573440
    s_mov_b32 exec_hi, 0x00ffffff
    buffer_load_dwordx4 v30, s[40:43], s95 offen lds
    s_mov_b32 exec_hi, -1
    s_mul_i32 s6, s17, 14848
    v_add_u32 v55, s6, v4
    ds_read_b128 a[40:43], v236 offset:2048
    s_mul_i32 s6, s18, 14848
    v_add_u32 v56, s6, v4
    s_mul_i32 s6, s19, 14848
    v_add_u32 v57, s6, v4
    v_lshlrev_b32 v4, 3, v2
    s_add_u32 m0, s96, 10208
    s_add_u32 s95, s85, 630784
    s_mov_b32 exec_hi, 0x00ffffff
    buffer_load_dwordx4 v30, s[40:43], s95 offen lds
    s_mov_b32 exec_hi, -1
    v_sub_u32 v5, v1, v4
    v_sub_u32 v6, 16, v1
    v_sub_u32 v6, v6, v4
    v_mov_b32 v7, 0x3f80
    ds_read_b128 a[44:47], v236 offset:3072
    v_mov_b32 v8, 0x3f800000
    v_mov_b32 v9, 0
    v_cmp_eq_u32 vcc, 0, v5
    v_cmp_eq_u32 s[6:7], 1, v5
    s_add_u32 m0, s96, 11136
    s_add_u32 s95, s85, 688128
    s_mov_b32 exec_hi, 0x00ffffff
    buffer_load_dwordx4 v30, s[40:43], s95 offen lds
    s_mov_b32 exec_hi, -1
    v_cndmask_b32 v42, v9, v7, vcc
    v_cndmask_b32 v42, v42, v8, s[6:7]
    v_cmp_eq_u32 vcc, 2, v5
    v_cmp_eq_u32 s[6:7], 3, v5
    ds_read_b128 a[48:51], v237 offset:0
    v_cndmask_b32 v43, v9, v7, vcc
    v_cndmask_b32 v43, v43, v8, s[6:7]
    v_cmp_eq_u32 vcc, 4, v5
    s_add_u32 m0, s96, 12064
    s_add_u32 s95, s85, 745472
    s_mov_b32 exec_hi, 0x00ffffff
    buffer_load_dwordx4 v30, s[40:43], s95 offen lds
    s_mov_b32 exec_hi, -1
    v_cmp_eq_u32 s[6:7], 5, v5
    v_cndmask_b32 v44, v9, v7, vcc
    s_nop 0
    v_cndmask_b32 v44, v44, v8, s[6:7]
    v_cmp_eq_u32 vcc, 6, v5
    v_cmp_eq_u32 s[6:7], 7, v5
    ds_read_b128 a[52:55], v237 offset:1024
    v_cndmask_b32 v45, v9, v7, vcc
    v_cndmask_b32 v45, v45, v8, s[6:7]
    v_cmp_eq_u32 vcc, 0, v6
    s_add_u32 m0, s96, 12992
    s_add_u32 s95, s85, 802816
    s_mov_b32 exec_hi, 0x00ffffff
    buffer_load_dwordx4 v30, s[40:43], s95 offen lds
    s_mov_b32 exec_hi, -1
    v_cmp_eq_u32 s[6:7], 1, v6
    v_cndmask_b32 v46, v9, v7, vcc
    s_nop 0
    v_cndmask_b32 v46, v46, v8, s[6:7]
    v_cmp_eq_u32 vcc, 2, v6
    v_cmp_eq_u32 s[6:7], 3, v6
    s_nop 0
    v_cndmask_b32 v47, v9, v7, vcc
    ds_read_b128 a[56:59], v237 offset:2048
    v_cndmask_b32 v47, v47, v8, s[6:7]
    s_add_u32 m0, s96, 13920
    s_add_u32 s95, s85, 860160
    s_mov_b32 exec_hi, 0x00ffffff
    buffer_load_dwordx4 v30, s[40:43], s95 offen lds
    s_mov_b32 exec_hi, -1
    v_cmp_eq_u32 vcc, 4, v6
    v_cmp_eq_u32 s[6:7], 5, v6
    s_nop 0
    v_cndmask_b32 v48, v9, v7, vcc
    v_cndmask_b32 v48, v48, v8, s[6:7]
    v_cmp_eq_u32 vcc, 6, v6
    v_cmp_eq_u32 s[6:7], 7, v6
    s_nop 0
    v_cndmask_b32 v49, v9, v7, vcc
    ds_read_b128 a[60:63], v237 offset:3072
    v_cndmask_b32 v49, v49, v8, s[6:7]
    buffer_store_dwordx4 v[60:63], v30, s[52:55], s79 offen offset:1024 sc1
    v_xor_b32 v50, 0x80008000, v46
    v_xor_b32 v51, 0x80008000, v47
    v_xor_b32 v52, 0x80008000, v48
    v_xor_b32 v53, 0x80008000, v49
    s_waitcnt vmcnt(18)
    s_mov_b32 s12, 0
L_b0_3:
    v_cmp_gt_u32 vcc, 63, v254
    s_nop 1
    s_cmp_eq_u64 vcc, 0
    s_cbranch_scc1 L_b0d_4
    s_add_u32 s12, s12, 1
    s_cmp_ge_u32 s12, 0x10000
    s_cbranch_scc1 L_b0d_4
    v_and_b32 v254, 3, v0
    v_lshlrev_b32 v254, 6, v254
    buffer_load_dword v254, v254, s[60:63], 0 offen sc1
    s_waitcnt vmcnt(0)
    s_branch L_b0_3
L_b0d_4:
    s_lshl_b32 s6, s5, 6
    s_lshl_b32 s7, s3, 4
    s_add_u32 s6, s6, s7
    v_lshl_add_u32 v8, v2, 2, s6
    buffer_load_dwordx2 v[64:65], v31, s[52:55], s24 offen offset:0 sc1
    s_lshl_b32 s6, s6, 8
    v_add_u32 v9, s6, v30
    v_mov_b32 v4, v8
    v_sub_u32 v6, 448, v4
    v_mov_b32 v7, 0
    v_cmp_eq_u32 vcc, 224, v4
    v_add_u32 v5, 0, v9
    s_nop 0
    v_cndmask_b32 v6, v6, v7, vcc
    buffer_load_dwordx2 v[66:67], v31, s[52:55], s24 offen offset:128 sc1
    v_lshrrev_b32 v7, 4, v6
    v_lshlrev_b32 v38, 12, v7
    v_bfe_u32 v7, v6, 2, 2
    v_lshl_add_u32 v7, v7, 4, v1
    v_lshl_add_u32 v38, v7, 4, v38
    v_and_b32 v7, 3, v6
    v_lshl_add_u32 v38, v7, 1, v38
    v_cmp_gt_u32 vcc, 224, v4
    buffer_load_dwordx2 v[68:69], v31, s[52:55], s24 offen offset:256 sc1
    v_add_u32 v38, 8, v38
    v_cndmask_b32 v38, v38, v5, vcc
    v_add_u32 v4, 1, v8
    v_sub_u32 v6, 448, v4
    v_mov_b32 v7, 0
    v_cmp_eq_u32 vcc, 224, v4
    v_add_u32 v5, 2, v9
    s_nop 0
    v_cndmask_b32 v6, v6, v7, vcc
    buffer_load_dwordx2 v[70:71], v31, s[52:55], s24 offen offset:384 sc1
    v_lshrrev_b32 v7, 4, v6
    v_lshlrev_b32 v39, 12, v7
    v_bfe_u32 v7, v6, 2, 2
    v_lshl_add_u32 v7, v7, 4, v1
    v_lshl_add_u32 v39, v7, 4, v39
    v_and_b32 v7, 3, v6
    v_lshl_add_u32 v39, v7, 1, v39
    v_cmp_gt_u32 vcc, 224, v4
    buffer_load_dwordx2 v[72:73], v31, s[52:55], s24 offen offset:2048 sc1
    v_add_u32 v39, 8, v39
    v_cndmask_b32 v39, v39, v5, vcc
    v_add_u32 v4, 2, v8
    v_sub_u32 v6, 448, v4
    v_mov_b32 v7, 0
    v_cmp_eq_u32 vcc, 224, v4
    v_add_u32 v5, 4, v9
    s_nop 0
    v_cndmask_b32 v6, v6, v7, vcc
    buffer_load_dwordx2 v[74:75], v31, s[52:55], s24 offen offset:2176 sc1
    v_lshrrev_b32 v7, 4, v6
    v_lshlrev_b32 v40, 12, v7
    v_bfe_u32 v7, v6, 2, 2
    v_lshl_add_u32 v7, v7, 4, v1
    v_lshl_add_u32 v40, v7, 4, v40
    v_and_b32 v7, 3, v6
    v_lshl_add_u32 v40, v7, 1, v40
    v_cmp_gt_u32 vcc, 224, v4
    buffer_load_dwordx2 v[76:77], v31, s[52:55], s24 offen offset:2304 sc1
    v_add_u32 v40, 8, v40
    v_cndmask_b32 v40, v40, v5, vcc
    v_add_u32 v4, 3, v8
    v_sub_u32 v6, 448, v4
    v_mov_b32 v7, 0
    v_cmp_eq_u32 vcc, 224, v4
    v_add_u32 v5, 6, v9
    s_nop 0
    v_cndmask_b32 v6, v6, v7, vcc
    buffer_load_dwordx2 v[78:79], v31, s[52:55], s24 offen offset:2432 sc1
    v_lshrrev_b32 v7, 4, v6
    v_lshlrev_b32 v41, 12, v7
    v_bfe_u32 v7, v6, 2, 2
    v_lshl_add_u32 v7, v7, 4, v1
    v_lshl_add_u32 v41, v7, 4, v41
    v_and_b32 v7, 3, v6
    v_lshl_add_u32 v41, v7, 1, v41
    v_cmp_gt_u32 vcc, 224, v4
    buffer_store_dwordx4 v[60:63], v30, s[52:55], s80 offen offset:0 sc1
    v_add_u32 v41, 8, v41
    v_cndmask_b32 v41, v41, v5, vcc
    s_lshl_b32 s94, s3, 13
    s_lshl_b32 s6, s5, 8
    s_lshl_b32 s7, s3, 6
    s_add_u32 s6, s6, s7
    s_mul_i32 s10, s6, 896
    s_mul_i32 s11, s4, 401408
    buffer_load_dwordx2 v[80:81], v31, s[52:55], s25 offen offset:0 sc1
    s_lshl_b32 s7, s3, 11
    s_add_u32 s11, s11, s7
    s_add_u32 s11, s11, 4194304
    s_mul_i32 s12, s5, 57344
    s_add_u32 s12, s12, s11
    s_add_u32 s6, s5, 1
    s_sub_u32 s7, s6, 7
    s_min_u32 s6, s6, s7
    buffer_load_dwordx2 v[82:83], v31, s[52:55], s25 offen offset:128 sc1
    s_lshl_b32 s7, s6, 7
    s_add_u32 s66, s10, s7
    s_lshl_b32 s7, s6, 13
    s_add_u32 s73, s12, s7
    s_add_u32 s6, s5, 2
    s_sub_u32 s7, s6, 7
    s_min_u32 s6, s6, s7
    s_lshl_b32 s7, s6, 7
    buffer_load_dwordx2 v[84:85], v31, s[52:55], s25 offen offset:256 sc1
    s_add_u32 s67, s10, s7
    s_lshl_b32 s7, s6, 13
    s_add_u32 s74, s12, s7
    s_add_u32 s6, s5, 3
    s_sub_u32 s7, s6, 7
    s_min_u32 s6, s6, s7
    s_lshl_b32 s7, s6, 7
    s_add_u32 s68, s10, s7
    buffer_load_dwordx2 v[86:87], v31, s[52:55], s25 offen offset:384 sc1
    s_lshl_b32 s7, s6, 13
    s_add_u32 s75, s12, s7
    s_add_u32 s6, s5, 4
    s_sub_u32 s7, s6, 7
    s_min_u32 s6, s6, s7
    s_lshl_b32 s7, s6, 7
    s_add_u32 s69, s10, s7
    s_lshl_b32 s7, s6, 13
    buffer_load_dwordx2 v[88:89], v31, s[52:55], s25 offen offset:2048 sc1
    s_add_u32 s76, s12, s7
    s_add_u32 s6, s5, 5
    s_sub_u32 s7, s6, 7
    s_min_u32 s6, s6, s7
    s_lshl_b32 s7, s6, 7
    s_add_u32 s70, s10, s7
    s_lshl_b32 s7, s6, 13
    s_add_u32 s77, s12, s7
    buffer_load_dwordx2 v[90:91], v31, s[52:55], s25 offen offset:2176 sc1
    s_add_u32 s6, s5, 6
    s_sub_u32 s7, s6, 7
    s_min_u32 s6, s6, s7
    s_lshl_b32 s7, s6, 7
    s_add_u32 s71, s10, s7
    s_lshl_b32 s7, s6, 13
    s_add_u32 s78, s12, s7
    s_add_u32 s6, s5, 7
    buffer_load_dwordx2 v[92:93], v31, s[52:55], s25 offen offset:2304 sc1
    s_sub_u32 s7, s6, 7
    s_min_u32 s6, s6, s7
    s_lshl_b32 s7, s6, 7
    s_add_u32 s72, s10, s7
    s_lshl_b32 s10, s5, 7
    s_lshl_b32 s7, s3, 5
    s_add_u32 s10, s10, s7
    s_sub_u32 s8, 64, s4
    buffer_load_dwordx2 v[94:95], v31, s[52:55], s25 offen offset:2432 sc1
    s_cmp_eq_u32 s4, 0
    s_cselect_b32 s8, 32, s8
    s_add_u32 s6, s4, 0
    s_mul_i32 s6, s6, 896
    s_add_u32 s86, s6, s10
    s_add_u32 s6, s4, 1024
    s_mul_i32 s6, s6, 896
    s_add_u32 s87, s6, s10
    s_add_u32 s6, s8, 0
    buffer_store_dwordx4 v[60:63], v30, s[52:55], s80 offen offset:1024 sc1
    s_mul_i32 s6, s6, 896
    s_add_u32 s88, s6, s10
    s_add_u32 s6, s8, 1024
    s_mul_i32 s6, s6, 896
    s_add_u32 s89, s6, s10
    s_waitcnt vmcnt(19)
    s_waitcnt lgkmcnt(0)
    s_barrier
    ds_read_b32 v240, v54 offset:448
    ds_read_b32 v244, v55 offset:448
    ds_read_b32 v248, v56 offset:448
    ds_read_b32 v252, v57 offset:448
    v_add_u32 v4, s90, v54
    v_add_u32 v5, s98, v54
    ds_read_b128 a[64:67], v4 offset:0
    ds_read_b128 a[68:71], v5 offset:0
    v_add_u32 v6, s91, v54
    v_add_u32 v7, s99, v54
    ds_read_b128 a[72:75], v6 offset:0
    ds_read_b128 a[76:79], v7 offset:0
    v_add_u32 v4, s92, v54
    v_add_u32 v5, s100, v54
    ds_read_b128 a[80:83], v4 offset:0
    ds_read_b128 a[84:87], v5 offset:0
    s_waitcnt lgkmcnt(4)
    v_mfma_f32_16x16x32_bf16 v[128:131], v[42:45], a[64:67], 0
    buffer_load_dwordx2 v[96:97], v31, s[52:55], s26 offen offset:0 sc1
    buffer_load_dwordx2 v[98:99], v31, s[52:55], s26 offen offset:128 sc1
    v_mfma_f32_16x16x32_bf16 v[176:179], v[42:45], a[64:67], 0
    v_add_u32 v6, s93, v54
    v_mfma_f32_16x16x32_bf16 v[128:131], v[46:49], a[68:71], v[128:131]
    v_add_u32 v7, s101, v54
    ds_read_b128 a[88:91], v6 offset:0
    v_mfma_f32_16x16x32_bf16 v[176:179], v[50:53], a[68:71], v[176:179]
    ds_read_b128 a[92:95], v7 offset:0
    s_waitcnt lgkmcnt(4)
    v_mfma_f32_16x16x32_bf16 v[144:147], v[42:45], a[72:75], 0
    buffer_load_dwordx2 v[100:101], v31, s[52:55], s26 offen offset:256 sc1
    buffer_load_dwordx2 v[102:103], v31, s[52:55], s26 offen offset:384 sc1
    v_mfma_f32_16x16x32_bf16 v[192:195], v[42:45], a[72:75], 0
    v_add_u32 v4, s90, v55
    v_mfma_f32_16x16x32_bf16 v[144:147], v[46:49], a[76:79], v[144:147]
    v_add_u32 v5, s98, v55
    ds_read_b128 a[64:67], v4 offset:0
    v_mfma_f32_16x16x32_bf16 v[192:195], v[50:53], a[76:79], v[192:195]
    ds_read_b128 a[68:71], v5 offset:0
    s_waitcnt lgkmcnt(4)
    v_mfma_f32_16x16x32_bf16 v[160:163], v[42:45], a[80:83], 0
    buffer_load_dwordx2 v[104:105], v31, s[52:55], s26 offen offset:2048 sc1
    buffer_load_dwordx2 v[106:107], v31, s[52:55], s26 offen offset:2176 sc1
    v_mfma_f32_16x16x32_bf16 v[208:211], v[42:45], a[80:83], 0
    v_add_u32 v6, s91, v55
    v_mfma_f32_16x16x32_bf16 v[160:163], v[46:49], a[84:87], v[160:163]
    v_add_u32 v7, s99, v55
    ds_read_b128 a[72:75], v6 offset:0
    v_mfma_f32_16x16x32_bf16 v[208:211], v[50:53], a[84:87], v[208:211]
    ds_read_b128 a[76:79], v7 offset:0
    s_waitcnt lgkmcnt(4)
    v_mfma_f32_16x16x32_bf16 v[224:227], v[42:45], a[88:91], 0
    buffer_load_dwordx2 v[108:109], v31, s[52:55], s26 offen offset:2304 sc1
    buffer_load_dwordx2 v[110:111], v31, s[52:55], s26 offen offset:2432 sc1
    v_mfma_f32_16x16x32_bf16 v[232:235], v[42:45], a[88:91], 0
    v_add_u32 v4, s92, v55
    v_mfma_f32_16x16x32_bf16 v[224:227], v[46:49], a[92:95], v[224:227]
    v_add_u32 v5, s100, v55
    ds_read_b128 a[80:83], v4 offset:0
    v_mfma_f32_16x16x32_bf16 v[232:235], v[50:53], a[92:95], v[232:235]
    ds_read_b128 a[84:87], v5 offset:0
    s_waitcnt lgkmcnt(4)
    v_mfma_f32_16x16x32_bf16 v[132:135], v[42:45], a[64:67], 0
    buffer_store_dwordx4 v[60:63], v30, s[52:55], s81 offen offset:0 sc1
    v_add_u32 v6, s93, v55
    v_mfma_f32_16x16x32_bf16 v[180:183], v[42:45], a[64:67], 0
    v_add_u32 v7, s101, v55
    v_mfma_f32_16x16x32_bf16 v[132:135], v[46:49], a[68:71], v[132:135]
    ds_read_b128 a[88:91], v6 offset:0
    v_mfma_f32_16x16x32_bf16 v[180:183], v[50:53], a[68:71], v[180:183]
    ds_read_b128 a[92:95], v7 offset:0
    s_waitcnt lgkmcnt(4)
    v_mfma_f32_16x16x32_bf16 v[148:151], v[42:45], a[72:75], 0
    buffer_load_dwordx2 v[112:113], v31, s[52:55], s27 offen offset:0 sc1
    v_add_u32 v4, s90, v56
    v_mfma_f32_16x16x32_bf16 v[196:199], v[42:45], a[72:75], 0
    v_add_u32 v5, s98, v56
    v_mfma_f32_16x16x32_bf16 v[148:151], v[46:49], a[76:79], v[148:151]
    ds_read_b128 a[64:67], v4 offset:0
    v_mfma_f32_16x16x32_bf16 v[196:199], v[50:53], a[76:79], v[196:199]
    ds_read_b128 a[68:71], v5 offset:0
    s_waitcnt lgkmcnt(4)
    v_mfma_f32_16x16x32_bf16 v[164:167], v[42:45], a[80:83], 0
    buffer_load_dwordx2 v[114:115], v31, s[52:55], s27 offen offset:128 sc1
    v_add_u32 v6, s91, v56
    v_mfma_f32_16x16x32_bf16 v[212:215], v[42:45], a[80:83], 0
    v_add_u32 v7, s99, v56
    v_mfma_f32_16x16x32_bf16 v[164:167], v[46:49], a[84:87], v[164:167]
    ds_read_b128 a[72:75], v6 offset:0
    v_mfma_f32_16x16x32_bf16 v[212:215], v[50:53], a[84:87], v[212:215]
    ds_read_b128 a[76:79], v7 offset:0
    s_waitcnt lgkmcnt(4)
    v_mfma_f32_16x16x32_bf16 v[228:231], v[42:45], a[88:91], 0
    buffer_load_dwordx2 v[116:117], v31, s[52:55], s27 offen offset:256 sc1
    v_add_u32 v4, s92, v56
    v_mfma_f32_16x16x32_bf16 v[236:239], v[42:45], a[88:91], 0
    v_add_u32 v5, s100, v56
    v_mfma_f32_16x16x32_bf16 v[228:231], v[46:49], a[92:95], v[228:231]
    ds_read_b128 a[80:83], v4 offset:0
    v_mfma_f32_16x16x32_bf16 v[236:239], v[50:53], a[92:95], v[236:239]
    ds_read_b128 a[84:87], v5 offset:0
    s_waitcnt lgkmcnt(4)
    v_mfma_f32_16x16x32_bf16 v[136:139], v[42:45], a[64:67], 0
    buffer_load_dwordx2 v[118:119], v31, s[52:55], s27 offen offset:384 sc1
    v_add_u32 v6, s90, v57
    v_mfma_f32_16x16x32_bf16 v[184:187], v[42:45], a[64:67], 0
    v_add_u32 v7, s98, v57
    v_mfma_f32_16x16x32_bf16 v[136:139], v[46:49], a[68:71], v[136:139]
    ds_read_b128 a[88:91], v6 offset:0
    v_mfma_f32_16x16x32_bf16 v[184:187], v[50:53], a[68:71], v[184:187]
    ds_read_b128 a[92:95], v7 offset:0
    s_waitcnt lgkmcnt(4)
    v_mfma_f32_16x16x32_bf16 v[152:155], v[42:45], a[72:75], 0
    buffer_load_dwordx2 v[120:121], v31, s[52:55], s27 offen offset:2048 sc1
    v_add_u32 v4, s91, v57
    v_mfma_f32_16x16x32_bf16 v[200:203], v[42:45], a[72:75], 0
    v_add_u32 v5, s99, v57
    v_mfma_f32_16x16x32_bf16 v[152:155], v[46:49], a[76:79], v[152:155]
    ds_read_b128 a[64:67], v4 offset:0
    v_mfma_f32_16x16x32_bf16 v[200:203], v[50:53], a[76:79], v[200:203]
    ds_read_b128 a[68:71], v5 offset:0
    s_waitcnt lgkmcnt(4)
    v_mfma_f32_16x16x32_bf16 v[168:171], v[42:45], a[80:83], 0
    buffer_load_dwordx2 v[122:123], v31, s[52:55], s27 offen offset:2176 sc1
    v_add_u32 v6, s92, v57
    v_mfma_f32_16x16x32_bf16 v[216:219], v[42:45], a[80:83], 0
    v_add_u32 v7, s100, v57
    v_mfma_f32_16x16x32_bf16 v[168:171], v[46:49], a[84:87], v[168:171]
    ds_read_b128 a[72:75], v6 offset:0
    v_mfma_f32_16x16x32_bf16 v[216:219], v[50:53], a[84:87], v[216:219]
    ds_read_b128 a[76:79], v7 offset:0
    s_waitcnt lgkmcnt(4)
    v_mfma_f32_16x16x32_bf16 v[140:143], v[42:45], a[88:91], 0
    buffer_load_dwordx2 v[124:125], v31, s[52:55], s27 offen offset:2304 sc1
    v_mfma_f32_16x16x32_bf16 v[188:191], v[42:45], a[88:91], 0
    v_mfma_f32_16x16x32_bf16 v[140:143], v[46:49], a[92:95], v[140:143]
    v_mfma_f32_16x16x32_bf16 v[188:191], v[50:53], a[92:95], v[188:191]
    s_waitcnt lgkmcnt(2)
    v_mfma_f32_16x16x32_bf16 v[156:159], v[42:45], a[64:67], 0
    buffer_load_dwordx2 v[126:127], v31, s[52:55], s27 offen offset:2432 sc1
    v_mfma_f32_16x16x32_bf16 v[204:207], v[42:45], a[64:67], 0
    v_mfma_f32_16x16x32_bf16 v[156:159], v[46:49], a[68:71], v[156:159]
    v_mfma_f32_16x16x32_bf16 v[204:207], v[50:53], a[68:71], v[204:207]
    s_waitcnt lgkmcnt(0)
    v_mfma_f32_16x16x32_bf16 v[172:175], v[42:45], a[72:75], 0
    buffer_store_dwordx4 v[60:63], v30, s[52:55], s81 offen offset:1024 sc1
    v_mfma_f32_16x16x32_bf16 v[220:223], v[42:45], a[72:75], 0
    v_mfma_f32_16x16x32_bf16 v[172:175], v[46:49], a[76:79], v[172:175]
    v_mfma_f32_16x16x32_bf16 v[220:223], v[50:53], a[76:79], v[220:223]
    s_nop 7
    v_mov_b32 v5, 0
    v_add_f32 v4, v128, v128
    v_cndmask_b32 v176, v176, v5, s[64:65]
    v_cndmask_b32 v128, v128, v4, s[64:65]
    v_lshlrev_b32 v240, 16, v240
    v_add_f32 v240, v240, v240
    v_add_f32 v4, v132, v132
    v_cndmask_b32 v180, v180, v5, s[64:65]
    v_cndmask_b32 v132, v132, v4, s[64:65]
    v_lshlrev_b32 v244, 16, v244
    v_add_f32 v244, v244, v244
    v_add_f32 v4, v136, v136
    v_cndmask_b32 v184, v184, v5, s[64:65]
    v_cndmask_b32 v136, v136, v4, s[64:65]
    v_lshlrev_b32 v248, 16, v248
    v_add_f32 v248, v248, v248
    v_add_f32 v4, v140, v140
    v_cndmask_b32 v188, v188, v5, s[64:65]
    v_cndmask_b32 v140, v140, v4, s[64:65]
    v_lshlrev_b32 v252, 16, v252
    v_add_f32 v252, v252, v252
    v_mov_b32 v50, 0x3f803f80
    v_mov_b32 v51, v50
    v_mov_b32 v52, v50
    v_mov_b32 v53, v50
    s_barrier
    s_waitcnt vmcnt(28)
    v_max3_u32 v4, v64, v65, v66
    v_max3_u32 v4, v4, v67, v68
    v_max3_u32 v4, v4, v69, v70
    v_max3_u32 v4, v4, v71, v72
    v_max3_u32 v4, v4, v73, v74
    v_max3_u32 v4, v4, v75, v76
    v_max3_u32 v4, v4, v77, v78
    v_max_u32 v4, v4, v79
    v_cmp_eq_u32 vcc, -1, v4
    s_nop 1
    s_cmp_eq_u64 vcc, 0
    s_cbranch_scc0 L_slow_5
L_back_6:
    v_swap_b32 v65, v66
    v_swap_b32 v66, v68
    v_swap_b32 v67, v70
    v_swap_b32 v69, v70
    v_swap_b32 v73, v74
    v_swap_b32 v74, v76
    v_swap_b32 v75, v78
    v_swap_b32 v77, v78
    s_cmp_eq_u32 s3, 0
    s_cbranch_scc0 L_noE_7
    v_mfma_f32_16x16x32_f16 v[240:243], v[68:71], a[0:3], v[240:243]
    v_mfma_f32_16x16x32_f16 v[244:247], v[68:71], a[16:19], v[244:247]
    v_mfma_f32_16x16x32_f16 v[248:251], v[68:71], a[32:35], v[248:251]
    v_mfma_f32_16x16x32_f16 v[252:255], v[68:71], a[48:51], v[252:255]
    v_mfma_f32_16x16x32_f16 v[240:243], v[76:79], a[8:11], v[240:243]
    v_mfma_f32_16x16x32_f16 v[244:247], v[76:79], a[24:27], v[244:247]
    v_mfma_f32_16x16x32_f16 v[248:251], v[76:79], a[40:43], v[248:251]
    v_mfma_f32_16x16x32_f16 v[252:255], v[76:79], a[56:59], v[252:255]
L_noE_7:
    v_mfma_f32_16x16x32_f16 v[128:131], v[64:67], a[0:3], v[128:131]
    s_add_u32 m0, s28, 0
    s_mov_b32 s95, s29
    v_mfma_f32_16x16x32_f16 v[176:179], v[68:71], a[4:7], v[176:179]
    buffer_load_dwordx4 v20, s[44:47], s95 offen lds
    v_mfma_f32_16x16x32_f16 v[128:131], v[72:75], a[8:11], v[128:131]
    buffer_load_dwordx4 v21, s[44:47], s95 offen offset:1024 lds
    v_mfma_f32_16x16x32_f16 v[176:179], v[76:79], a[12:15], v[176:179]
    buffer_load_dwordx4 v3, s[44:47], s29 offen offset:2048 lds
    v_mfma_f32_16x16x32_f16 v[132:135], v[64:67], a[16:19], v[132:135]
    s_add_u32 s96, s29, 1547776
    v_mfma_f32_16x16x32_f16 v[180:183], v[68:71], a[20:23], v[180:183]
    buffer_load_dwordx4 v23, s[44:47], s96 offen offset:3072 lds
    v_mfma_f32_16x16x32_f16 v[132:135], v[72:75], a[24:27], v[132:135]
    buffer_store_dwordx4 v[60:63], v30, s[52:55], s82 offen offset:0 sc1
    s_add_u32 m0, s28, 4096
    s_add_u32 s95, s29, 57344
    v_mfma_f32_16x16x32_f16 v[180:183], v[76:79], a[28:31], v[180:183]
    buffer_load_dwordx4 v20, s[44:47], s95 offen lds
    v_mfma_f32_16x16x32_f16 v[136:139], v[64:67], a[32:35], v[136:139]
    v_add_f32 v4, v128, v176
    v_sub_f32 v8, v128, v176
    v_add_f32 v5, v129, v177
    v_sub_f32 v9, v129, v177
    buffer_load_dwordx4 v21, s[44:47], s95 offen offset:1024 lds
    v_mfma_f32_16x16x32_f16 v[184:187], v[68:71], a[36:39], v[184:187]
    v_add_f32 v6, v130, v178
    v_sub_f32 v10, v130, v178
    v_add_f32 v7, v131, v179
    v_sub_f32 v11, v131, v179
    v_mfma_f32_16x16x32_f16 v[136:139], v[72:75], a[40:43], v[136:139]
    v_cndmask_b32 v4, v4, v128, s[64:65]
    v_cndmask_b32 v8, v8, v240, s[64:65]
    v_cvt_pk_bf16_f32 v128, v4, v5
    v_cvt_pk_bf16_f32 v129, v6, v7
    s_add_u32 s96, s29, 1490432
    v_mfma_f32_16x16x32_f16 v[184:187], v[76:79], a[44:47], v[184:187]
    v_cvt_pk_bf16_f32 v130, v8, v9
    v_cvt_pk_bf16_f32 v131, v10, v11
    ds_write_b128 v32, v[128:131] offset:0
    buffer_load_dwordx4 v22, s[44:47], s96 offen offset:2048 lds
    v_mfma_f32_16x16x32_f16 v[140:143], v[64:67], a[48:51], v[140:143]
    v_add_f32 v4, v132, v180
    v_sub_f32 v8, v132, v180
    v_add_f32 v5, v133, v181
    v_sub_f32 v9, v133, v181
    buffer_load_dwordx4 v23, s[44:47], s96 offen offset:3072 lds
    v_mfma_f32_16x16x32_f16 v[188:191], v[68:71], a[52:55], v[188:191]
    v_add_f32 v6, v134, v182
    v_sub_f32 v10, v134, v182
    v_add_f32 v7, v135, v183
    v_sub_f32 v11, v135, v183
    v_mfma_f32_16x16x32_f16 v[140:143], v[72:75], a[56:59], v[140:143]
    v_cndmask_b32 v4, v4, v132, s[64:65]
    v_cndmask_b32 v8, v8, v244, s[64:65]
    v_cvt_pk_bf16_f32 v132, v4, v5
    buffer_store_dwordx4 v[60:63], v30, s[52:55], s82 offen offset:1024 sc1
    v_mfma_f32_16x16x32_f16 v[188:191], v[76:79], a[60:63], v[188:191]
    v_cvt_pk_bf16_f32 v133, v6, v7
    v_cvt_pk_bf16_f32 v134, v8, v9
    v_cvt_pk_bf16_f32 v135, v10, v11
    ds_write_b128 v33, v[132:135] offset:0
    s_waitcnt vmcnt(29)
    v_max3_u32 v4, v80, v81, v82
    v_max3_u32 v4, v4, v83, v84
    v_max3_u32 v4, v4, v85, v86
    v_max3_u32 v4, v4, v87, v88
    v_max3_u32 v4, v4, v89, v90
    v_max3_u32 v4, v4, v91, v92
    v_max3_u32 v4, v4, v93, v94
    v_max_u32 v4, v4, v95
    v_cmp_eq_u32 vcc, -1, v4
    s_nop 1
    s_cmp_eq_u64 vcc, 0
    s_cbranch_scc0 L_slow_8
L_back_9:
    v_swap_b32 v81, v82
    v_swap_b32 v82, v84
    v_swap_b32 v83, v86
    v_swap_b32 v85, v86
    v_swap_b32 v89, v90
    v_swap_b32 v90, v92
    v_swap_b32 v91, v94
    v_swap_b32 v93, v94
    v_mfma_f32_16x16x32_f16 v[144:147], v[80:83], a[0:3], v[144:147]
    v_add_f32 v4, v136, v184
    v_sub_f32 v8, v136, v184
    v_add_f32 v5, v137, v185
    s_add_u32 m0, s28, 8192
    s_add_u32 s95, s29, 114688
    v_mfma_f32_16x16x32_f16 v[192:195], v[84:87], a[4:7], v[192:195]
    v_sub_f32 v9, v137, v185
    v_add_f32 v6, v138, v186
    v_sub_f32 v10, v138, v186
    v_add_f32 v7, v139, v187
    buffer_load_dwordx4 v20, s[44:47], s95 offen lds
    v_mfma_f32_16x16x32_f16 v[144:147], v[88:91], a[8:11], v[144:147]
    v_sub_f32 v11, v139, v187
    v_cndmask_b32 v4, v4, v136, s[64:65]
    v_cndmask_b32 v8, v8, v248, s[64:65]
    v_cvt_pk_bf16_f32 v136, v4, v5
    buffer_load_dwordx4 v21, s[44:47], s95 offen offset:1024 lds
    v_mfma_f32_16x16x32_f16 v[192:195], v[92:95], a[12:15], v[192:195]
    v_cvt_pk_bf16_f32 v137, v6, v7
    v_cvt_pk_bf16_f32 v138, v8, v9
    v_cvt_pk_bf16_f32 v139, v10, v11
    ds_write_b128 v34, v[136:139] offset:0
    v_mfma_f32_16x16x32_f16 v[148:151], v[80:83], a[16:19], v[148:151]
    v_add_f32 v4, v140, v188
    v_sub_f32 v8, v140, v188
    v_add_f32 v5, v141, v189
    v_sub_f32 v9, v141, v189
    s_add_u32 s96, s29, 1433088
    v_mfma_f32_16x16x32_f16 v[196:199], v[84:87], a[20:23], v[196:199]
    v_add_f32 v6, v142, v190
    v_sub_f32 v10, v142, v190
    v_add_f32 v7, v143, v191
    v_sub_f32 v11, v143, v191
    buffer_load_dwordx4 v22, s[44:47], s96 offen offset:2048 lds
    v_mfma_f32_16x16x32_f16 v[148:151], v[88:91], a[24:27], v[148:151]
    v_cndmask_b32 v4, v4, v140, s[64:65]
    v_cndmask_b32 v8, v8, v252, s[64:65]
    v_cvt_pk_bf16_f32 v140, v4, v5
    buffer_load_dwordx4 v23, s[44:47], s96 offen offset:3072 lds
    v_mfma_f32_16x16x32_f16 v[196:199], v[92:95], a[28:31], v[196:199]
    v_cvt_pk_bf16_f32 v141, v6, v7
    v_cvt_pk_bf16_f32 v142, v8, v9
    v_cvt_pk_bf16_f32 v143, v10, v11
    ds_write_b128 v35, v[140:143] offset:0
    v_mfma_f32_16x16x32_f16 v[152:155], v[80:83], a[32:35], v[152:155]
    v_add_f32 v4, v144, v192
    v_sub_f32 v8, v144, v192
    v_add_f32 v5, v145, v193
    v_sub_f32 v9, v145, v193
    buffer_store_dwordx4 v[60:63], v30, s[52:55], s83 offen offset:0 sc1
    v_mfma_f32_16x16x32_f16 v[200:203], v[84:87], a[36:39], v[200:203]
    v_add_f32 v6, v146, v194
    v_sub_f32 v10, v146, v194
    v_add_f32 v7, v147, v195
    v_sub_f32 v11, v147, v195
    v_mfma_f32_16x16x32_f16 v[152:155], v[88:91], a[40:43], v[152:155]
    v_cvt_pk_bf16_f32 v144, v4, v5
    v_cvt_pk_bf16_f32 v145, v6, v7
    s_add_u32 m0, s28, 12288
    s_add_u32 s95, s29, 172032
    v_mfma_f32_16x16x32_f16 v[200:203], v[92:95], a[44:47], v[200:203]
    v_cvt_pk_bf16_f32 v146, v8, v9
    v_cvt_pk_bf16_f32 v147, v10, v11
    ds_write_b128 v32, v[144:147] offset:4096
    buffer_load_dwordx4 v20, s[44:47], s95 offen lds
    v_mfma_f32_16x16x32_f16 v[156:159], v[80:83], a[48:51], v[156:159]
    v_add_f32 v4, v148, v196
    v_sub_f32 v8, v148, v196
    v_add_f32 v5, v149, v197
    v_sub_f32 v9, v149, v197
    buffer_load_dwordx4 v21, s[44:47], s95 offen offset:1024 lds
    v_mfma_f32_16x16x32_f16 v[204:207], v[84:87], a[52:55], v[204:207]
    v_add_f32 v6, v150, v198
    v_sub_f32 v10, v150, v198
    v_add_f32 v7, v151, v199
    v_mfma_f32_16x16x32_f16 v[156:159], v[88:91], a[56:59], v[156:159]
    v_sub_f32 v11, v151, v199
    v_cvt_pk_bf16_f32 v148, v4, v5
    v_cvt_pk_bf16_f32 v149, v6, v7
    s_add_u32 s96, s29, 1375744
    v_mfma_f32_16x16x32_f16 v[204:207], v[92:95], a[60:63], v[204:207]
    v_cvt_pk_bf16_f32 v150, v8, v9
    v_cvt_pk_bf16_f32 v151, v10, v11
    ds_write_b128 v33, v[148:151] offset:4096
    buffer_load_dwordx4 v22, s[44:47], s96 offen offset:2048 lds
    s_waitcnt vmcnt(28)
    v_max3_u32 v4, v96, v97, v98
    v_max3_u32 v4, v4, v99, v100
    v_max3_u32 v4, v4, v101, v102
    v_max3_u32 v4, v4, v103, v104
    v_max3_u32 v4, v4, v105, v106
    v_max3_u32 v4, v4, v107, v108
    v_max3_u32 v4, v4, v109, v110
    v_max_u32 v4, v4, v111
    v_cmp_eq_u32 vcc, -1, v4
    s_nop 1
    s_cmp_eq_u64 vcc, 0
    s_cbranch_scc0 L_slow_10
L_back_11:
    v_swap_b32 v97, v98
    v_swap_b32 v98, v100
    v_swap_b32 v99, v102
    v_swap_b32 v101, v102
    v_swap_b32 v105, v106
    v_swap_b32 v106, v108
    v_swap_b32 v107, v110
    v_swap_b32 v109, v110
    v_mfma_f32_16x16x32_f16 v[160:163], v[96:99], a[0:3], v[160:163]
    v_add_f32 v4, v152, v200
    v_sub_f32 v8, v152, v200
    v_add_f32 v5, v153, v201
    buffer_load_dwordx4 v23, s[44:47], s96 offen offset:3072 lds
    v_mfma_f32_16x16x32_f16 v[208:211], v[100:103], a[4:7], v[208:211]
    v_sub_f32 v9, v153, v201
    v_add_f32 v6, v154, v202
    v_sub_f32 v10, v154, v202
    v_add_f32 v7, v155, v203
    v_mfma_f32_16x16x32_f16 v[160:163], v[104:107], a[8:11], v[160:163]
    v_sub_f32 v11, v155, v203
    v_cvt_pk_bf16_f32 v152, v4, v5
    v_cvt_pk_bf16_f32 v153, v6, v7
    buffer_store_dwordx4 v[60:63], v30, s[52:55], s83 offen offset:1024 sc1
    v_mfma_f32_16x16x32_f16 v[208:211], v[108:111], a[12:15], v[208:211]
    v_cvt_pk_bf16_f32 v154, v8, v9
    v_cvt_pk_bf16_f32 v155, v10, v11
    ds_write_b128 v34, v[152:155] offset:4096
    v_mfma_f32_16x16x32_f16 v[164:167], v[96:99], a[16:19], v[164:167]
    v_add_f32 v4, v156, v204
    v_sub_f32 v8, v156, v204
    v_add_f32 v5, v157, v205
    s_add_u32 m0, s28, 16384
    s_add_u32 s95, s29, 229376
    v_mfma_f32_16x16x32_f16 v[212:215], v[100:103], a[20:23], v[212:215]
    v_sub_f32 v9, v157, v205
    v_add_f32 v6, v158, v206
    v_sub_f32 v10, v158, v206
    buffer_load_dwordx4 v20, s[44:47], s95 offen lds
    v_mfma_f32_16x16x32_f16 v[164:167], v[104:107], a[24:27], v[164:167]
    v_add_f32 v7, v159, v207
    v_sub_f32 v11, v159, v207
    v_cvt_pk_bf16_f32 v156, v4, v5
    buffer_load_dwordx4 v21, s[44:47], s95 offen offset:1024 lds
    v_mfma_f32_16x16x32_f16 v[212:215], v[108:111], a[28:31], v[212:215]
    v_cvt_pk_bf16_f32 v157, v6, v7
    v_cvt_pk_bf16_f32 v158, v8, v9
    v_cvt_pk_bf16_f32 v159, v10, v11
    ds_write_b128 v35, v[156:159] offset:4096
    v_mfma_f32_16x16x32_f16 v[168:171], v[96:99], a[32:35], v[168:171]
    v_add_f32 v4, v160, v208
    v_sub_f32 v8, v160, v208
    v_add_f32 v5, v161, v209
    v_sub_f32 v9, v161, v209
    s_add_u32 s96, s29, 1318400
    v_mfma_f32_16x16x32_f16 v[216:219], v[100:103], a[36:39], v[216:219]
    v_add_f32 v6, v162, v210
    v_sub_f32 v10, v162, v210
    v_add_f32 v7, v163, v211
    buffer_load_dwordx4 v22, s[44:47], s96 offen offset:2048 lds
    v_mfma_f32_16x16x32_f16 v[168:171], v[104:107], a[40:43], v[168:171]
    v_sub_f32 v11, v163, v211
    v_cvt_pk_bf16_f32 v160, v4, v5
    v_cvt_pk_bf16_f32 v161, v6, v7
    buffer_load_dwordx4 v23, s[44:47], s96 offen offset:3072 lds
    v_mfma_f32_16x16x32_f16 v[216:219], v[108:111], a[44:47], v[216:219]
    v_cvt_pk_bf16_f32 v162, v8, v9
    v_cvt_pk_bf16_f32 v163, v10, v11
    ds_write_b128 v32, v[160:163] offset:8192
    v_mfma_f32_16x16x32_f16 v[172:175], v[96:99], a[48:51], v[172:175]
    v_add_f32 v4, v164, v212
    v_sub_f32 v8, v164, v212
    v_add_f32 v5, v165, v213
    v_sub_f32 v9, v165, v213
    buffer_store_dwordx4 v[60:63], v30, s[52:55], s84 offen offset:0 sc1
    v_mfma_f32_16x16x32_f16 v[220:223], v[100:103], a[52:55], v[220:223]
    v_add_f32 v6, v166, v214
    v_sub_f32 v10, v166, v214
    v_add_f32 v7, v167, v215
    v_sub_f32 v11, v167, v215
    v_mfma_f32_16x16x32_f16 v[172:175], v[104:107], a[56:59], v[172:175]
    v_cvt_pk_bf16_f32 v164, v4, v5
    v_cvt_pk_bf16_f32 v165, v6, v7
    s_add_u32 m0, s28, 20480
    s_add_u32 s95, s29, 286720
    v_mfma_f32_16x16x32_f16 v[220:223], v[108:111], a[60:63], v[220:223]
    v_cvt_pk_bf16_f32 v166, v8, v9
    v_cvt_pk_bf16_f32 v167, v10, v11
    ds_write_b128 v33, v[164:167] offset:8192
    buffer_load_dwordx4 v20, s[44:47], s95 offen lds
    s_waitcnt vmcnt(27)
    v_max3_u32 v4, v112, v113, v114
    v_max3_u32 v4, v4, v115, v116
    v_max3_u32 v4, v4, v117, v118
    v_max3_u32 v4, v4, v119, v120
    v_max3_u32 v4, v4, v121, v122
    v_max3_u32 v4, v4, v123, v124
    v_max3_u32 v4, v4, v125, v126
    v_max_u32 v4, v4, v127
    v_cmp_eq_u32 vcc, -1, v4
    s_nop 1
    s_cmp_eq_u64 vcc, 0
    s_cbranch_scc0 L_slow_12
L_back_13:
    v_swap_b32 v113, v114
    v_swap_b32 v114, v116
    v_swap_b32 v115, v118
    v_swap_b32 v117, v118
    v_swap_b32 v121, v122
    v_swap_b32 v122, v124
    v_swap_b32 v123, v126
    v_swap_b32 v125, v126
    v_mfma_f32_16x16x32_f16 v[224:227], v[112:115], a[0:3], v[224:227]
    v_add_f32 v4, v168, v216
    v_sub_f32 v8, v168, v216
    v_add_f32 v5, v169, v217
    v_sub_f32 v9, v169, v217
    buffer_load_dwordx4 v21, s[44:47], s95 offen offset:1024 lds
    v_mfma_f32_16x16x32_f16 v[232:235], v[116:119], a[4:7], v[232:235]
    v_add_f32 v6, v170, v218
    v_sub_f32 v10, v170, v218
    v_add_f32 v7, v171, v219
    v_mfma_f32_16x16x32_f16 v[224:227], v[120:123], a[8:11], v[224:227]
    v_sub_f32 v11, v171, v219
    v_cvt_pk_bf16_f32 v168, v4, v5
    v_cvt_pk_bf16_f32 v169, v6, v7
    s_add_u32 s96, s29, 1261056
    v_mfma_f32_16x16x32_f16 v[232:235], v[124:127], a[12:15], v[232:235]
    v_cvt_pk_bf16_f32 v170, v8, v9
    v_cvt_pk_bf16_f32 v171, v10, v11
    ds_write_b128 v34, v[168:171] offset:8192
    buffer_load_dwordx4 v22, s[44:47], s96 offen offset:2048 lds
    v_mfma_f32_16x16x32_f16 v[228:231], v[112:115], a[16:19], v[228:231]
    v_add_f32 v4, v172, v220
    v_sub_f32 v8, v172, v220
    v_add_f32 v5, v173, v221
    buffer_load_dwordx4 v23, s[44:47], s96 offen offset:3072 lds
    v_mfma_f32_16x16x32_f16 v[236:239], v[116:119], a[20:23], v[236:239]
    v_sub_f32 v9, v173, v221
    v_add_f32 v6, v174, v222
    v_sub_f32 v10, v174, v222
    v_add_f32 v7, v175, v223
    v_mfma_f32_16x16x32_f16 v[228:231], v[120:123], a[24:27], v[228:231]
    v_sub_f32 v11, v175, v223
    v_cvt_pk_bf16_f32 v172, v4, v5
    v_cvt_pk_bf16_f32 v173, v6, v7
    buffer_store_dwordx4 v[60:63], v30, s[52:55], s84 offen offset:1024 sc1
    v_mfma_f32_16x16x32_f16 v[236:239], v[124:127], a[28:31], v[236:239]
    v_cvt_pk_bf16_f32 v174, v8, v9
    v_cvt_pk_bf16_f32 v175, v10, v11
    ds_write_b128 v35, v[172:175] offset:8192
    v_add_f32 v4, v224, v232
    v_sub_f32 v8, v224, v232
    v_add_f32 v5, v225, v233
    v_sub_f32 v9, v225, v233
    v_add_f32 v6, v226, v234
    v_sub_f32 v10, v226, v234
    v_add_f32 v7, v227, v235
    v_sub_f32 v11, v227, v235
    v_cvt_pk_bf16_f32 v224, v4, v5
    v_cvt_pk_bf16_f32 v225, v6, v7
    v_cvt_pk_bf16_f32 v226, v8, v9
    v_cvt_pk_bf16_f32 v227, v10, v11
    ds_write_b128 v36, v[224:227] offset:0
    v_add_f32 v4, v228, v236
    v_sub_f32 v8, v228, v236
    v_add_f32 v5, v229, v237
    v_sub_f32 v9, v229, v237
    v_add_f32 v6, v230, v238
    v_sub_f32 v10, v230, v238
    v_add_f32 v7, v231, v239
    v_sub_f32 v11, v231, v239
    v_cvt_pk_bf16_f32 v228, v4, v5
    v_cvt_pk_bf16_f32 v229, v6, v7
    v_cvt_pk_bf16_f32 v230, v8, v9
    v_cvt_pk_bf16_f32 v231, v10, v11
    ds_write_b128 v37, v[228:231] offset:0
    s_lshl_b32 s6, s5, 10
    s_lshl_b32 s7, s3, 8
    s_add_u32 s6, s6, s7
    s_add_u32 s97, s6, 2097152
    v_lshlrev_b32 v31, 4, v2
    s_waitcnt vmcnt(26)
    ds_read_b64_tr_b16 v[192:193], v16 offset:0
    ds_read_b64_tr_b16 v[194:195], v16 offset:2048
    ds_read_b64_tr_b16 v[196:197], v17 offset:0
    ds_read_b64_tr_b16 v[198:199], v17 offset:2048
    ds_read_b64_tr_b16 v[200:201], v18 offset:0
    ds_read_b64_tr_b16 v[202:203], v18 offset:2048
    ds_read_b64_tr_b16 v[204:205], v19 offset:0
    ds_read_b64_tr_b16 v[206:207], v19 offset:2048
    s_waitcnt lgkmcnt(0)
    s_barrier
    ds_read_b128 v[224:227], v12 offset:0
    ds_read_b128 v[228:231], v13 offset:0
    ds_read_b128 v[232:235], v14 offset:0
    ds_read_b128 v[236:239], v15 offset:0
    s_waitcnt lgkmcnt(0)
    v_mfma_f32_16x16x32_bf16 v[46:49], v[224:227], v[224:227], 0
    s_add_u32 m0, s28, 0
    s_add_u32 s95, s29, 344064
    v_mfma_f32_16x16x32_bf16 v[42:45], v[50:53], v[224:227], 0
    s_waitcnt vmcnt(21)
    buffer_load_dwordx4 v20, s[44:47], s95 offen lds
    v_mfma_f32_16x16x32_bf16 v[128:131], v[192:195], v[224:227], 0
    ds_read_b128 v[240:243], v12 offset:4096
    v_mfma_f32_16x16x32_bf16 v[144:147], v[196:199], v[224:227], 0
    ds_read_b128 v[244:247], v13 offset:4096
    buffer_load_dwordx4 v21, s[44:47], s95 offen offset:1024 lds
    v_mfma_f32_16x16x32_bf16 v[160:163], v[200:203], v[224:227], 0
    ds_read_b128 v[248:251], v14 offset:4096
    v_mfma_f32_16x16x32_bf16 v[176:179], v[204:207], v[224:227], 0
    ds_read_b128 v[252:255], v15 offset:4096
    v_mfma_f32_16x16x32_bf16 v[132:135], v[192:195], v[228:231], 0
    ds_read_b64_tr_b16 v[208:209], v16 offset:4096
    s_lshl_b32 s6, s3, 13
    v_mfma_f32_16x16x32_bf16 v[148:151], v[196:199], v[228:231], 0
    ds_read_b64_tr_b16 v[210:211], v16 offset:6144
    s_add_u32 s96, s29, 1203712
    v_mfma_f32_16x16x32_bf16 v[164:167], v[200:203], v[228:231], 0
    ds_read_b64_tr_b16 v[212:213], v17 offset:4096
    buffer_load_dwordx4 v22, s[44:47], s96 offen offset:2048 lds
    v_mfma_f32_16x16x32_bf16 v[180:183], v[204:207], v[228:231], 0
    ds_read_b64_tr_b16 v[214:215], v17 offset:6144
    v_mfma_f32_16x16x32_bf16 v[136:139], v[192:195], v[232:235], 0
    ds_read_b64_tr_b16 v[216:217], v18 offset:4096
    buffer_load_dwordx4 v23, s[44:47], s96 offen offset:3072 lds
    v_mfma_f32_16x16x32_bf16 v[152:155], v[196:199], v[232:235], 0
    ds_read_b64_tr_b16 v[218:219], v18 offset:6144
    v_mfma_f32_16x16x32_bf16 v[168:171], v[200:203], v[232:235], 0
    ds_read_b64_tr_b16 v[220:221], v19 offset:4096
    v_add_u32 v54, s6, v12
    v_mfma_f32_16x16x32_bf16 v[184:187], v[204:207], v[232:235], 0
    ds_read_b64_tr_b16 v[222:223], v19 offset:6144
    v_mfma_f32_16x16x32_bf16 v[140:143], v[192:195], v[236:239], 0
    buffer_load_dwordx4 v[64:67], v31, s[52:55], s97 offen offset:0 sc1
    v_mfma_f32_16x16x32_bf16 v[156:159], v[196:199], v[236:239], 0
    v_add_u32 v55, s6, v13
    v_mfma_f32_16x16x32_bf16 v[172:175], v[200:203], v[236:239], 0
    v_add_u32 v56, s6, v14
    v_mfma_f32_16x16x32_bf16 v[188:191], v[204:207], v[236:239], 0
    s_waitcnt lgkmcnt(0)
    v_mfma_f32_16x16x32_bf16 v[46:49], v[240:243], v[240:243], v[46:49]
    s_add_u32 m0, s28, 4096
    s_add_u32 s95, s29, 401408
    v_mfma_f32_16x16x32_bf16 v[42:45], v[50:53], v[240:243], v[42:45]
    s_waitcnt vmcnt(21)
    buffer_load_dwordx4 v20, s[44:47], s95 offen lds
    v_mfma_f32_16x16x32_bf16 v[128:131], v[208:211], v[240:243], v[128:131]
    ds_read_b128 v[224:227], v12 offset:8192
    v_mfma_f32_16x16x32_bf16 v[144:147], v[212:215], v[240:243], v[144:147]
    ds_read_b128 v[228:231], v13 offset:8192
    buffer_load_dwordx4 v21, s[44:47], s95 offen offset:1024 lds
    v_mfma_f32_16x16x32_bf16 v[160:163], v[216:219], v[240:243], v[160:163]
    ds_read_b128 v[232:235], v14 offset:8192
    v_mfma_f32_16x16x32_bf16 v[176:179], v[220:223], v[240:243], v[176:179]
    ds_read_b128 v[236:239], v15 offset:8192
    v_mfma_f32_16x16x32_bf16 v[132:135], v[208:211], v[244:247], v[132:135]
    ds_read_b64_tr_b16 v[192:193], v16 offset:8192
    v_add_u32 v57, s6, v15
    v_mfma_f32_16x16x32_bf16 v[148:151], v[212:215], v[244:247], v[148:151]
    ds_read_b64_tr_b16 v[194:195], v16 offset:10240
    s_add_u32 s96, s29, 1146368
    v_mfma_f32_16x16x32_bf16 v[164:167], v[216:219], v[244:247], v[164:167]
    ds_read_b64_tr_b16 v[196:197], v17 offset:8192
    buffer_load_dwordx4 v22, s[44:47], s96 offen offset:2048 lds
    v_mfma_f32_16x16x32_bf16 v[180:183], v[220:223], v[244:247], v[180:183]
    ds_read_b64_tr_b16 v[198:199], v17 offset:10240
    v_mfma_f32_16x16x32_bf16 v[136:139], v[208:211], v[248:251], v[136:139]
    ds_read_b64_tr_b16 v[200:201], v18 offset:8192
    buffer_load_dwordx4 v23, s[44:47], s96 offen offset:3072 lds
    v_mfma_f32_16x16x32_bf16 v[152:155], v[212:215], v[248:251], v[152:155]
    ds_read_b64_tr_b16 v[202:203], v18 offset:10240
    v_mfma_f32_16x16x32_bf16 v[168:171], v[216:219], v[248:251], v[168:171]
    ds_read_b64_tr_b16 v[204:205], v19 offset:8192
    v_lshlrev_b32 v36, 2, v1
    v_mfma_f32_16x16x32_bf16 v[184:187], v[220:223], v[248:251], v[184:187]
    ds_read_b64_tr_b16 v[206:207], v19 offset:10240
    v_mfma_f32_16x16x32_bf16 v[140:143], v[208:211], v[252:255], v[140:143]
    buffer_load_dwordx4 v[68:71], v31, s[52:55], s97 offen offset:64 sc1
    v_mfma_f32_16x16x32_bf16 v[156:159], v[212:215], v[252:255], v[156:159]
    v_add_u32 v36, 157696, v36
    v_mfma_f32_16x16x32_bf16 v[172:175], v[216:219], v[252:255], v[172:175]
    s_lshl_b32 s6, s3, 6
    v_mfma_f32_16x16x32_bf16 v[188:191], v[220:223], v[252:255], v[188:191]
    s_waitcnt lgkmcnt(0)
    v_mfma_f32_16x16x32_bf16 v[46:49], v[224:227], v[224:227], v[46:49]
    s_add_u32 m0, s28, 8192
    s_add_u32 s95, s29, 458752
    v_mfma_f32_16x16x32_bf16 v[42:45], v[50:53], v[224:227], v[42:45]
    s_waitcnt vmcnt(21)
    buffer_load_dwordx4 v20, s[44:47], s95 offen lds
    v_mfma_f32_16x16x32_bf16 v[128:131], v[192:195], v[224:227], v[128:131]
    ds_read_b128 v[240:243], v12 offset:12288
    v_mfma_f32_16x16x32_bf16 v[144:147], v[196:199], v[224:227], v[144:147]
    ds_read_b128 v[244:247], v13 offset:12288
    buffer_load_dwordx4 v21, s[44:47], s95 offen offset:1024 lds
    v_mfma_f32_16x16x32_bf16 v[160:163], v[200:203], v[224:227], v[160:163]
    ds_read_b128 v[248:251], v14 offset:12288
    v_mfma_f32_16x16x32_bf16 v[176:179], v[204:207], v[224:227], v[176:179]
    ds_read_b128 v[252:255], v15 offset:12288
    v_mfma_f32_16x16x32_bf16 v[132:135], v[192:195], v[228:231], v[132:135]
    ds_read_b64_tr_b16 v[208:209], v16 offset:12288
    v_add_u32 v37, s6, v36
    v_mfma_f32_16x16x32_bf16 v[148:151], v[196:199], v[228:231], v[148:151]
    ds_read_b64_tr_b16 v[210:211], v16 offset:14336
    s_add_u32 s96, s29, 1089024
    v_mfma_f32_16x16x32_bf16 v[164:167], v[200:203], v[228:231], v[164:167]
    ds_read_b64_tr_b16 v[212:213], v17 offset:12288
    buffer_load_dwordx4 v22, s[44:47], s96 offen offset:2048 lds
    v_mfma_f32_16x16x32_bf16 v[180:183], v[204:207], v[228:231], v[180:183]
    ds_read_b64_tr_b16 v[214:215], v17 offset:14336
    v_mfma_f32_16x16x32_bf16 v[136:139], v[192:195], v[232:235], v[136:139]
    ds_read_b64_tr_b16 v[216:217], v18 offset:12288
    buffer_load_dwordx4 v23, s[44:47], s96 offen offset:3072 lds
    v_mfma_f32_16x16x32_bf16 v[152:155], v[196:199], v[232:235], v[152:155]
    ds_read_b64_tr_b16 v[218:219], v18 offset:14336
    v_mfma_f32_16x16x32_bf16 v[168:171], v[200:203], v[232:235], v[168:171]
    ds_read_b64_tr_b16 v[220:221], v19 offset:12288
    v_add_u32 v4, s5, v0
    v_mfma_f32_16x16x32_bf16 v[184:187], v[204:207], v[232:235], v[184:187]
    ds_read_b64_tr_b16 v[222:223], v19 offset:14336
    v_mfma_f32_16x16x32_bf16 v[140:143], v[192:195], v[236:239], v[140:143]
    buffer_load_dwordx4 v[72:75], v31, s[52:55], s97 offen offset:128 sc1
    v_mfma_f32_16x16x32_bf16 v[156:159], v[196:199], v[236:239], v[156:159]
    v_add_u32 v4, 1, v4
    v_mfma_f32_16x16x32_bf16 v[172:175], v[200:203], v[236:239], v[172:175]
    v_subrev_u32 v5, 7, v4
    v_mfma_f32_16x16x32_bf16 v[188:191], v[204:207], v[236:239], v[188:191]
    s_waitcnt lgkmcnt(0)
    v_mfma_f32_16x16x32_bf16 v[46:49], v[240:243], v[240:243], v[46:49]
    s_add_u32 m0, s28, 12288
    s_add_u32 s95, s29, 516096
    v_mfma_f32_16x16x32_bf16 v[42:45], v[50:53], v[240:243], v[42:45]
    s_waitcnt vmcnt(21)
    buffer_load_dwordx4 v20, s[44:47], s95 offen lds
    v_mfma_f32_16x16x32_bf16 v[128:131], v[208:211], v[240:243], v[128:131]
    ds_read_b128 v[224:227], v12 offset:16384
    v_mfma_f32_16x16x32_bf16 v[144:147], v[212:215], v[240:243], v[144:147]
    ds_read_b128 v[228:231], v13 offset:16384
    buffer_load_dwordx4 v21, s[44:47], s95 offen offset:1024 lds
    v_mfma_f32_16x16x32_bf16 v[160:163], v[216:219], v[240:243], v[160:163]
    ds_read_b128 v[232:235], v14 offset:16384
    v_mfma_f32_16x16x32_bf16 v[176:179], v[220:223], v[240:243], v[176:179]
    ds_read_b128 v[236:239], v15 offset:16384
    v_mfma_f32_16x16x32_bf16 v[132:135], v[208:211], v[244:247], v[132:135]
    ds_read_b64_tr_b16 v[192:193], v16 offset:16384
    v_cmp_le_u32 vcc, 7, v4
    v_mfma_f32_16x16x32_bf16 v[148:151], v[212:215], v[244:247], v[148:151]
    ds_read_b64_tr_b16 v[194:195], v16 offset:18432
    s_add_u32 s96, s29, 1031680
    v_mfma_f32_16x16x32_bf16 v[164:167], v[216:219], v[244:247], v[164:167]
    ds_read_b64_tr_b16 v[196:197], v17 offset:16384
    buffer_load_dwordx4 v22, s[44:47], s96 offen offset:2048 lds
    v_mfma_f32_16x16x32_bf16 v[180:183], v[220:223], v[244:247], v[180:183]
    ds_read_b64_tr_b16 v[198:199], v17 offset:18432
    v_mfma_f32_16x16x32_bf16 v[136:139], v[208:211], v[248:251], v[136:139]
    ds_read_b64_tr_b16 v[200:201], v18 offset:16384
    buffer_load_dwordx4 v23, s[44:47], s96 offen offset:3072 lds
    v_mfma_f32_16x16x32_bf16 v[152:155], v[212:215], v[248:251], v[152:155]
    ds_read_b64_tr_b16 v[202:203], v18 offset:18432
    v_mfma_f32_16x16x32_bf16 v[168:171], v[216:219], v[248:251], v[168:171]
    ds_read_b64_tr_b16 v[204:205], v19 offset:16384
    s_mul_i32 s6, s4, 7
    v_mfma_f32_16x16x32_bf16 v[184:187], v[220:223], v[248:251], v[184:187]
    ds_read_b64_tr_b16 v[206:207], v19 offset:18432
    v_mfma_f32_16x16x32_bf16 v[140:143], v[208:211], v[252:255], v[140:143]
    buffer_load_dwordx4 v[76:79], v31, s[52:55], s97 offen offset:192 sc1
    v_mfma_f32_16x16x32_bf16 v[156:159], v[212:215], v[252:255], v[156:159]
    v_cndmask_b32 v4, v4, v5, vcc
    v_mfma_f32_16x16x32_bf16 v[172:175], v[216:219], v[252:255], v[172:175]
    v_add_u32 v4, s6, v4
    v_mfma_f32_16x16x32_bf16 v[188:191], v[220:223], v[252:255], v[188:191]
    s_waitcnt lgkmcnt(0)
    v_mfma_f32_16x16x32_bf16 v[46:49], v[224:227], v[224:227], v[46:49]
    s_add_u32 m0, s28, 16384
    s_add_u32 s95, s29, 573440
    v_mfma_f32_16x16x32_bf16 v[42:45], v[50:53], v[224:227], v[42:45]
    s_waitcnt vmcnt(21)
    buffer_load_dwordx4 v20, s[44:47], s95 offen lds
    v_mfma_f32_16x16x32_bf16 v[128:131], v[192:195], v[224:227], v[128:131]
    ds_read_b128 v[240:243], v12 offset:20480
    v_mfma_f32_16x16x32_bf16 v[144:147], v[196:199], v[224:227], v[144:147]
    ds_read_b128 v[244:247], v13 offset:20480
    v_mfma_f32_16x16x32_bf16 v[160:163], v[200:203], v[224:227], v[160:163]
    ds_read_b128 v[248:251], v14 offset:20480
    buffer_load_dwordx4 v21, s[44:47], s95 offen offset:1024 lds
    v_mfma_f32_16x16x32_bf16 v[176:179], v[204:207], v[224:227], v[176:179]
    ds_read_b128 v[252:255], v15 offset:20480
    v_mfma_f32_16x16x32_bf16 v[132:135], v[192:195], v[228:231], v[132:135]
    ds_read_b64_tr_b16 v[208:209], v16 offset:20480
    v_lshlrev_b32 v4, 9, v4
    v_mfma_f32_16x16x32_bf16 v[148:151], v[196:199], v[228:231], v[148:151]
    ds_read_b64_tr_b16 v[210:211], v16 offset:22528
    v_mfma_f32_16x16x32_bf16 v[164:167], v[200:203], v[228:231], v[164:167]
    ds_read_b64_tr_b16 v[212:213], v17 offset:20480
    v_mfma_f32_16x16x32_bf16 v[180:183], v[204:207], v[228:231], v[180:183]
    ds_read_b64_tr_b16 v[214:215], v17 offset:22528
    s_add_u32 s96, s29, 974336
    v_mfma_f32_16x16x32_bf16 v[136:139], v[192:195], v[232:235], v[136:139]
    ds_read_b64_tr_b16 v[216:217], v18 offset:20480
    buffer_load_dwordx4 v22, s[44:47], s96 offen offset:2048 lds
    v_mfma_f32_16x16x32_bf16 v[152:155], v[196:199], v[232:235], v[152:155]
    ds_read_b64_tr_b16 v[218:219], v18 offset:22528
    v_mfma_f32_16x16x32_bf16 v[168:171], v[200:203], v[232:235], v[168:171]
    ds_read_b64_tr_b16 v[220:221], v19 offset:20480
    s_lshl_b32 s6, s3, 7
    v_mfma_f32_16x16x32_bf16 v[184:187], v[204:207], v[232:235], v[184:187]
    ds_read_b64_tr_b16 v[222:223], v19 offset:22528
    buffer_load_dwordx4 v23, s[44:47], s96 offen offset:3072 lds
    v_mfma_f32_16x16x32_bf16 v[140:143], v[192:195], v[236:239], v[140:143]
    v_mfma_f32_16x16x32_bf16 v[156:159], v[196:199], v[236:239], v[156:159]
    s_add_u32 s6, s6, 2228224
    v_mfma_f32_16x16x32_bf16 v[172:175], v[200:203], v[236:239], v[172:175]
    v_mfma_f32_16x16x32_bf16 v[188:191], v[204:207], v[236:239], v[188:191]
    s_waitcnt lgkmcnt(0)
    v_mfma_f32_16x16x32_bf16 v[46:49], v[240:243], v[240:243], v[46:49]
    s_add_u32 m0, s28, 20480
    s_add_u32 s95, s29, 630784
    v_mfma_f32_16x16x32_bf16 v[42:45], v[50:53], v[240:243], v[42:45]
    s_waitcnt vmcnt(20)
    buffer_load_dwordx4 v20, s[44:47], s95 offen lds
    v_mfma_f32_16x16x32_bf16 v[128:131], v[208:211], v[240:243], v[128:131]
    ds_read_b128 v[224:227], v12 offset:24576
    v_mfma_f32_16x16x32_bf16 v[144:147], v[212:215], v[240:243], v[144:147]
    ds_read_b128 v[228:231], v13 offset:24576
    v_mfma_f32_16x16x32_bf16 v[160:163], v[216:219], v[240:243], v[160:163]
    ds_read_b128 v[232:235], v14 offset:24576
    buffer_load_dwordx4 v21, s[44:47], s95 offen offset:1024 lds
    v_mfma_f32_16x16x32_bf16 v[176:179], v[220:223], v[240:243], v[176:179]
    ds_read_b128 v[236:239], v15 offset:24576
    v_mfma_f32_16x16x32_bf16 v[132:135], v[208:211], v[244:247], v[132:135]
    ds_read_b64_tr_b16 v[192:193], v16 offset:0
    v_add_u32 v10, s6, v4
    v_mfma_f32_16x16x32_bf16 v[148:151], v[212:215], v[244:247], v[148:151]
    ds_read_b64_tr_b16 v[194:195], v16 offset:2048
    v_mfma_f32_16x16x32_bf16 v[164:167], v[216:219], v[244:247], v[164:167]
    ds_read_b64_tr_b16 v[196:197], v17 offset:0
    v_mfma_f32_16x16x32_bf16 v[180:183], v[220:223], v[244:247], v[180:183]
    ds_read_b64_tr_b16 v[198:199], v17 offset:2048
    s_add_u32 s96, s29, 916992
    v_mfma_f32_16x16x32_bf16 v[136:139], v[208:211], v[248:251], v[136:139]
    ds_read_b64_tr_b16 v[200:201], v18 offset:0
    buffer_load_dwordx4 v22, s[44:47], s96 offen offset:2048 lds
    v_mfma_f32_16x16x32_bf16 v[152:155], v[212:215], v[248:251], v[152:155]
    ds_read_b64_tr_b16 v[202:203], v18 offset:2048
    v_mfma_f32_16x16x32_bf16 v[168:171], v[216:219], v[248:251], v[168:171]
    ds_read_b64_tr_b16 v[204:205], v19 offset:0
    s_mul_i32 s13, s4, 7
    v_mfma_f32_16x16x32_bf16 v[184:187], v[220:223], v[248:251], v[184:187]
    ds_read_b64_tr_b16 v[206:207], v19 offset:2048
    buffer_load_dwordx4 v23, s[44:47], s96 offen offset:3072 lds
    v_mfma_f32_16x16x32_bf16 v[140:143], v[208:211], v[252:255], v[140:143]
    v_mfma_f32_16x16x32_bf16 v[156:159], v[212:215], v[252:255], v[156:159]
    s_add_u32 s13, s13, s5
    v_mfma_f32_16x16x32_bf16 v[172:175], v[216:219], v[252:255], v[172:175]
    v_mfma_f32_16x16x32_bf16 v[188:191], v[220:223], v[252:255], v[188:191]
    s_waitcnt lgkmcnt(0)
    v_mfma_f32_16x16x32_bf16 v[46:49], v[224:227], v[224:227], v[46:49]
    s_add_u32 m0, s28, 0
    s_add_u32 s95, s29, 688128
    v_mfma_f32_16x16x32_bf16 v[42:45], v[50:53], v[224:227], v[42:45]
    s_waitcnt vmcnt(19)
    buffer_load_dwordx4 v20, s[44:47], s95 offen lds
    v_mfma_f32_16x16x32_bf16 v[128:131], v[192:195], v[224:227], v[128:131]
    ds_read_b128 v[240:243], v12 offset:28672
    v_mfma_f32_16x16x32_bf16 v[144:147], v[196:199], v[224:227], v[144:147]
    ds_read_b128 v[244:247], v13 offset:28672
    v_mfma_f32_16x16x32_bf16 v[160:163], v[200:203], v[224:227], v[160:163]
    ds_read_b128 v[248:251], v14 offset:28672
    buffer_load_dwordx4 v21, s[44:47], s95 offen offset:1024 lds
    v_mfma_f32_16x16x32_bf16 v[176:179], v[204:207], v[224:227], v[176:179]
    ds_read_b128 v[252:255], v15 offset:28672
    v_mfma_f32_16x16x32_bf16 v[132:135], v[192:195], v[228:231], v[132:135]
    ds_read_b64_tr_b16 v[208:209], v16 offset:4096
    s_lshl_b32 s13, s13, 2
    v_mfma_f32_16x16x32_bf16 v[148:151], v[196:199], v[228:231], v[148:151]
    ds_read_b64_tr_b16 v[210:211], v16 offset:6144
    v_mfma_f32_16x16x32_bf16 v[164:167], v[200:203], v[228:231], v[164:167]
    ds_read_b64_tr_b16 v[212:213], v17 offset:4096
    v_mfma_f32_16x16x32_bf16 v[180:183], v[204:207], v[228:231], v[180:183]
    ds_read_b64_tr_b16 v[214:215], v17 offset:6144
    s_add_u32 s96, s29, 859648
    v_mfma_f32_16x16x32_bf16 v[136:139], v[192:195], v[232:235], v[136:139]
    ds_read_b64_tr_b16 v[216:217], v18 offset:4096
    buffer_load_dwordx4 v22, s[44:47], s96 offen offset:2048 lds
    v_mfma_f32_16x16x32_bf16 v[152:155], v[196:199], v[232:235], v[152:155]
    ds_read_b64_tr_b16 v[218:219], v18 offset:6144
    v_mfma_f32_16x16x32_bf16 v[168:171], v[200:203], v[232:235], v[168:171]
    ds_read_b64_tr_b16 v[220:221], v19 offset:4096
    s_add_u32 s13, s13, s3
    v_mfma_f32_16x16x32_bf16 v[184:187], v[204:207], v[232:235], v[184:187]
    ds_read_b64_tr_b16 v[222:223], v19 offset:6144
    buffer_load_dwordx4 v23, s[44:47], s96 offen offset:3072 lds
    v_mfma_f32_16x16x32_bf16 v[140:143], v[192:195], v[236:239], v[140:143]
    v_mfma_f32_16x16x32_bf16 v[156:159], v[196:199], v[236:239], v[156:159]
    s_lshl_b32 s13, s13, 7
    v_mfma_f32_16x16x32_bf16 v[172:175], v[200:203], v[236:239], v[172:175]
    v_mfma_f32_16x16x32_bf16 v[188:191], v[204:207], v[236:239], v[188:191]
    s_waitcnt lgkmcnt(0)
    v_mfma_f32_16x16x32_bf16 v[46:49], v[240:243], v[240:243], v[46:49]
    s_add_u32 m0, s28, 4096
    s_add_u32 s95, s29, 745472
    v_mfma_f32_16x16x32_bf16 v[42:45], v[50:53], v[240:243], v[42:45]
    s_waitcnt vmcnt(18)
    buffer_load_dwordx4 v20, s[44:47], s95 offen lds
    v_mfma_f32_16x16x32_bf16 v[128:131], v[208:211], v[240:243], v[128:131]
    ds_read_b128 v[224:227], v12 offset:32768
    v_mfma_f32_16x16x32_bf16 v[144:147], v[212:215], v[240:243], v[144:147]
    ds_read_b128 v[228:231], v13 offset:32768
    v_mfma_f32_16x16x32_bf16 v[160:163], v[216:219], v[240:243], v[160:163]
    ds_read_b128 v[232:235], v14 offset:32768
    buffer_load_dwordx4 v21, s[44:47], s95 offen offset:1024 lds
    v_mfma_f32_16x16x32_bf16 v[176:179], v[220:223], v[240:243], v[176:179]
    ds_read_b128 v[236:239], v15 offset:32768
    v_mfma_f32_16x16x32_bf16 v[132:135], v[208:211], v[244:247], v[132:135]
    ds_read_b64_tr_b16 v[192:193], v16 offset:8192
    s_add_u32 s13, s13, 2228224
    v_mfma_f32_16x16x32_bf16 v[148:151], v[212:215], v[244:247], v[148:151]
    ds_read_b64_tr_b16 v[194:195], v16 offset:10240
    v_mfma_f32_16x16x32_bf16 v[164:167], v[216:219], v[244:247], v[164:167]
    ds_read_b64_tr_b16 v[196:197], v17 offset:8192
    v_mfma_f32_16x16x32_bf16 v[180:183], v[220:223], v[244:247], v[180:183]
    ds_read_b64_tr_b16 v[198:199], v17 offset:10240
    s_add_u32 s96, s29, 802304
    v_mfma_f32_16x16x32_bf16 v[136:139], v[208:211], v[248:251], v[136:139]
    ds_read_b64_tr_b16 v[200:201], v18 offset:8192
    buffer_load_dwordx4 v22, s[44:47], s96 offen offset:2048 lds
    v_mfma_f32_16x16x32_bf16 v[152:155], v[212:215], v[248:251], v[152:155]
    ds_read_b64_tr_b16 v[202:203], v18 offset:10240
    v_mfma_f32_16x16x32_bf16 v[168:171], v[216:219], v[248:251], v[168:171]
    ds_read_b64_tr_b16 v[204:205], v19 offset:8192
    v_mov_b32 v9, 1
    v_mfma_f32_16x16x32_bf16 v[184:187], v[220:223], v[248:251], v[184:187]
    ds_read_b64_tr_b16 v[206:207], v19 offset:10240
    buffer_load_dwordx4 v23, s[44:47], s96 offen offset:3072 lds
    v_mfma_f32_16x16x32_bf16 v[140:143], v[208:211], v[252:255], v[140:143]
    v_mfma_f32_16x16x32_bf16 v[156:159], v[212:215], v[252:255], v[156:159]
    v_mov_b32 v8, 0
    v_mfma_f32_16x16x32_bf16 v[172:175], v[216:219], v[252:255], v[172:175]
    v_mfma_f32_16x16x32_bf16 v[188:191], v[220:223], v[252:255], v[188:191]
    s_waitcnt lgkmcnt(0)
    v_mfma_f32_16x16x32_bf16 v[46:49], v[224:227], v[224:227], v[46:49]
    s_waitcnt vmcnt(17)
    s_add_u32 m0, s28, 8192
    v_mfma_f32_16x16x32_bf16 v[42:45], v[50:53], v[224:227], v[42:45]
    ds_read_b128 v[240:243], v12 offset:36864
    buffer_load_dwordx4 v24, s[48:51], s66 offen lds
    v_mfma_f32_16x16x32_bf16 v[128:131], v[192:195], v[224:227], v[128:131]
    ds_read_b128 v[244:247], v13 offset:36864
    v_mfma_f32_16x16x32_bf16 v[144:147], v[196:199], v[224:227], v[144:147]
    ds_read_b128 v[248:251], v14 offset:36864
    v_mfma_f32_16x16x32_bf16 v[160:163], v[200:203], v[224:227], v[160:163]
    ds_read_b128 v[252:255], v15 offset:36864
    buffer_load_dwordx4 v25, s[48:51], s66 offen offset:1024 lds
    v_mfma_f32_16x16x32_bf16 v[176:179], v[204:207], v[224:227], v[176:179]
    ds_read_b64_tr_b16 v[208:209], v16 offset:12288
    v_mfma_f32_16x16x32_bf16 v[132:135], v[192:195], v[228:231], v[132:135]
    ds_read_b64_tr_b16 v[210:211], v16 offset:14336
    v_mov_b32 v80, 0
    v_mov_b32 v81, 0
    v_mfma_f32_16x16x32_bf16 v[148:151], v[196:199], v[228:231], v[148:151]
    ds_read_b64_tr_b16 v[212:213], v17 offset:12288
    v_mov_b32 v82, 0
    v_mfma_f32_16x16x32_bf16 v[164:167], v[200:203], v[228:231], v[164:167]
    ds_read_b64_tr_b16 v[214:215], v17 offset:14336
    v_mov_b32 v83, 0
    v_mfma_f32_16x16x32_bf16 v[180:183], v[204:207], v[228:231], v[180:183]
    ds_read_b64_tr_b16 v[216:217], v18 offset:12288
    buffer_load_dwordx4 v26, s[48:51], s66 offen offset:2048 lds
    v_mfma_f32_16x16x32_bf16 v[136:139], v[192:195], v[232:235], v[136:139]
    ds_read_b64_tr_b16 v[218:219], v18 offset:14336
    v_mov_b32 v84, 0
    v_mfma_f32_16x16x32_bf16 v[152:155], v[196:199], v[232:235], v[152:155]
    ds_read_b64_tr_b16 v[220:221], v19 offset:12288
    v_mov_b32 v85, 0
    v_mfma_f32_16x16x32_bf16 v[168:171], v[200:203], v[232:235], v[168:171]
    ds_read_b64_tr_b16 v[222:223], v19 offset:14336
    v_mov_b32 v86, 0
    v_mfma_f32_16x16x32_bf16 v[184:187], v[204:207], v[232:235], v[184:187]
    v_mov_b32 v87, 0
    buffer_load_dwordx4 v27, s[48:51], s66 offen offset:3072 lds
    v_mfma_f32_16x16x32_bf16 v[140:143], v[192:195], v[236:239], v[140:143]
    v_mov_b32 v88, 0
    v_mov_b32 v89, 0
    v_mfma_f32_16x16x32_bf16 v[156:159], v[196:199], v[236:239], v[156:159]
    v_mov_b32 v90, 0
    v_mov_b32 v91, 0
    v_mfma_f32_16x16x32_bf16 v[172:175], v[200:203], v[236:239], v[172:175]
    v_mov_b32 v92, 0
    v_mov_b32 v93, 0
    v_mfma_f32_16x16x32_bf16 v[188:191], v[204:207], v[236:239], v[188:191]
    v_mov_b32 v94, 0
    v_mov_b32 v95, 0
    s_waitcnt lgkmcnt(0)
    v_mfma_f32_16x16x32_bf16 v[46:49], v[240:243], v[240:243], v[46:49]
    s_add_u32 m0, s28, 12288
    s_add_u32 s95, s66, 28672
    v_mfma_f32_16x16x32_bf16 v[42:45], v[50:53], v[240:243], v[42:45]
    s_waitcnt vmcnt(16)
    buffer_load_dwordx4 v24, s[48:51], s95 offen lds
    v_mfma_f32_16x16x32_bf16 v[128:131], v[208:211], v[240:243], v[128:131]
    ds_read_b128 v[224:227], v12 offset:40960
    v_mfma_f32_16x16x32_bf16 v[144:147], v[212:215], v[240:243], v[144:147]
    ds_read_b128 v[228:231], v13 offset:40960
    v_mfma_f32_16x16x32_bf16 v[160:163], v[216:219], v[240:243], v[160:163]
    ds_read_b128 v[232:235], v14 offset:40960
    buffer_load_dwordx4 v25, s[48:51], s95 offen offset:1024 lds
    v_mfma_f32_16x16x32_bf16 v[176:179], v[220:223], v[240:243], v[176:179]
    ds_read_b128 v[236:239], v15 offset:40960
    v_mfma_f32_16x16x32_bf16 v[132:135], v[208:211], v[244:247], v[132:135]
    ds_read_b64_tr_b16 v[192:193], v16 offset:16384
    ds_read_u16_d16_hi v80, v38 offset:0
    v_mfma_f32_16x16x32_bf16 v[148:151], v[212:215], v[244:247], v[148:151]
    ds_read_b64_tr_b16 v[194:195], v16 offset:18432
    ds_read_u16_d16_hi v81, v39 offset:0
    v_mfma_f32_16x16x32_bf16 v[164:167], v[216:219], v[244:247], v[164:167]
    ds_read_b64_tr_b16 v[196:197], v17 offset:16384
    v_mfma_f32_16x16x32_bf16 v[180:183], v[220:223], v[244:247], v[180:183]
    ds_read_b64_tr_b16 v[198:199], v17 offset:18432
    buffer_load_dwordx4 v26, s[48:51], s95 offen offset:2048 lds
    v_mfma_f32_16x16x32_bf16 v[136:139], v[208:211], v[248:251], v[136:139]
    ds_read_b64_tr_b16 v[200:201], v18 offset:16384
    ds_read_u16_d16_hi v82, v40 offset:0
    v_mfma_f32_16x16x32_bf16 v[152:155], v[212:215], v[248:251], v[152:155]
    ds_read_b64_tr_b16 v[202:203], v18 offset:18432
    v_mfma_f32_16x16x32_bf16 v[168:171], v[216:219], v[248:251], v[168:171]
    ds_read_b64_tr_b16 v[204:205], v19 offset:16384
    ds_read_u16_d16_hi v83, v41 offset:0
    v_mfma_f32_16x16x32_bf16 v[184:187], v[220:223], v[248:251], v[184:187]
    ds_read_b64_tr_b16 v[206:207], v19 offset:18432
    buffer_load_dwordx4 v27, s[48:51], s95 offen offset:3072 lds
    v_mfma_f32_16x16x32_bf16 v[140:143], v[208:211], v[252:255], v[140:143]
    ds_read_u16_d16_hi v84, v38 offset:1024
    v_mfma_f32_16x16x32_bf16 v[156:159], v[212:215], v[252:255], v[156:159]
    ds_read_u16_d16_hi v85, v39 offset:1024
    v_mfma_f32_16x16x32_bf16 v[172:175], v[216:219], v[252:255], v[172:175]
    ds_read_u16_d16_hi v86, v40 offset:1024
    v_mfma_f32_16x16x32_bf16 v[188:191], v[220:223], v[252:255], v[188:191]
    ds_read_u16_d16_hi v87, v41 offset:1024
    s_waitcnt lgkmcnt(4)
    v_mfma_f32_16x16x32_bf16 v[46:49], v[224:227], v[224:227], v[46:49]
    s_waitcnt vmcnt(16)
    s_add_u32 m0, s28, 16384
    v_mfma_f32_16x16x32_bf16 v[42:45], v[50:53], v[224:227], v[42:45]
    ds_read_b128 v[240:243], v12 offset:45056
    buffer_load_dwordx4 v24, s[48:51], s67 offen lds
    v_mfma_f32_16x16x32_bf16 v[128:131], v[192:195], v[224:227], v[128:131]
    ds_read_b128 v[244:247], v13 offset:45056
    v_mfma_f32_16x16x32_bf16 v[144:147], v[196:199], v[224:227], v[144:147]
    ds_read_b128 v[248:251], v14 offset:45056
    v_mfma_f32_16x16x32_bf16 v[160:163], v[200:203], v[224:227], v[160:163]
    ds_read_b128 v[252:255], v15 offset:45056
    buffer_load_dwordx4 v25, s[48:51], s67 offen offset:1024 lds
    v_mfma_f32_16x16x32_bf16 v[176:179], v[204:207], v[224:227], v[176:179]
    ds_read_b64_tr_b16 v[208:209], v16 offset:20480
    v_mfma_f32_16x16x32_bf16 v[132:135], v[192:195], v[228:231], v[132:135]
    ds_read_b64_tr_b16 v[210:211], v16 offset:22528
    ds_read_u16_d16_hi v88, v38 offset:2048
    v_mfma_f32_16x16x32_bf16 v[148:151], v[196:199], v[228:231], v[148:151]
    ds_read_b64_tr_b16 v[212:213], v17 offset:20480
    ds_read_u16_d16_hi v89, v39 offset:2048
    v_mfma_f32_16x16x32_bf16 v[164:167], v[200:203], v[228:231], v[164:167]
    ds_read_b64_tr_b16 v[214:215], v17 offset:22528
    v_mfma_f32_16x16x32_bf16 v[180:183], v[204:207], v[228:231], v[180:183]
    ds_read_b64_tr_b16 v[216:217], v18 offset:20480
    buffer_load_dwordx4 v26, s[48:51], s67 offen offset:2048 lds
    v_mfma_f32_16x16x32_bf16 v[136:139], v[192:195], v[232:235], v[136:139]
    ds_read_b64_tr_b16 v[218:219], v18 offset:22528
    ds_read_u16_d16_hi v90, v40 offset:2048
    v_mfma_f32_16x16x32_bf16 v[152:155], v[196:199], v[232:235], v[152:155]
    ds_read_b64_tr_b16 v[220:221], v19 offset:20480
    v_mfma_f32_16x16x32_bf16 v[168:171], v[200:203], v[232:235], v[168:171]
    ds_read_b64_tr_b16 v[222:223], v19 offset:22528
    ds_read_u16_d16_hi v91, v41 offset:2048
    v_mfma_f32_16x16x32_bf16 v[184:187], v[204:207], v[232:235], v[184:187]
    buffer_load_dwordx4 v27, s[48:51], s67 offen offset:3072 lds
    v_mfma_f32_16x16x32_bf16 v[140:143], v[192:195], v[236:239], v[140:143]
    ds_read_u16_d16_hi v92, v38 offset:3072
    v_mfma_f32_16x16x32_bf16 v[156:159], v[196:199], v[236:239], v[156:159]
    ds_read_u16_d16_hi v93, v39 offset:3072
    v_mfma_f32_16x16x32_bf16 v[172:175], v[200:203], v[236:239], v[172:175]
    ds_read_u16_d16_hi v94, v40 offset:3072
    v_mfma_f32_16x16x32_bf16 v[188:191], v[204:207], v[236:239], v[188:191]
    ds_read_u16_d16_hi v95, v41 offset:3072
    s_waitcnt lgkmcnt(5)
    v_mfma_f32_16x16x32_bf16 v[46:49], v[240:243], v[240:243], v[46:49]
    s_add_u32 m0, s28, 20480
    s_add_u32 s95, s67, 28672
    v_mfma_f32_16x16x32_bf16 v[42:45], v[50:53], v[240:243], v[42:45]
    s_waitcnt vmcnt(16)
    buffer_load_dwordx4 v24, s[48:51], s95 offen lds
    v_mfma_f32_16x16x32_bf16 v[128:131], v[208:211], v[240:243], v[128:131]
    ds_read_b128 v[224:227], v12 offset:49152
    v_mfma_f32_16x16x32_bf16 v[144:147], v[212:215], v[240:243], v[144:147]
    ds_read_b128 v[228:231], v13 offset:49152
    v_mfma_f32_16x16x32_bf16 v[160:163], v[216:219], v[240:243], v[160:163]
    ds_read_b128 v[232:235], v14 offset:49152
    buffer_load_dwordx4 v25, s[48:51], s95 offen offset:1024 lds
    v_mfma_f32_16x16x32_bf16 v[176:179], v[220:223], v[240:243], v[176:179]
    ds_read_b128 v[236:239], v15 offset:49152
    v_mfma_f32_16x16x32_bf16 v[132:135], v[208:211], v[244:247], v[132:135]
    ds_read_b64_tr_b16 v[192:193], v16 offset:0
    s_mov_b64 exec, 1
    buffer_store_dword v9, v8, s[52:55], s13 offen sc1
    s_mov_b64 exec, -1
    v_mfma_f32_16x16x32_bf16 v[148:151], v[212:215], v[244:247], v[148:151]
    ds_read_b64_tr_b16 v[194:195], v16 offset:2048
    v_mfma_f32_16x16x32_bf16 v[164:167], v[216:219], v[244:247], v[164:167]
    ds_read_b64_tr_b16 v[196:197], v17 offset:0
    v_mfma_f32_16x16x32_bf16 v[180:183], v[220:223], v[244:247], v[180:183]
    ds_read_b64_tr_b16 v[198:199], v17 offset:2048
    buffer_load_dwordx4 v26, s[48:51], s95 offen offset:2048 lds
    v_mfma_f32_16x16x32_bf16 v[136:139], v[208:211], v[248:251], v[136:139]
    ds_read_b64_tr_b16 v[200:201], v18 offset:0
    v_mfma_f32_16x16x32_bf16 v[152:155], v[212:215], v[248:251], v[152:155]
    ds_read_b64_tr_b16 v[202:203], v18 offset:2048
    v_mfma_f32_16x16x32_bf16 v[168:171], v[216:219], v[248:251], v[168:171]
    ds_read_b64_tr_b16 v[204:205], v19 offset:0
    v_mfma_f32_16x16x32_bf16 v[184:187], v[220:223], v[248:251], v[184:187]
    ds_read_b64_tr_b16 v[206:207], v19 offset:2048
    buffer_load_dwordx4 v27, s[48:51], s95 offen offset:3072 lds
    v_mfma_f32_16x16x32_bf16 v[140:143], v[208:211], v[252:255], v[140:143]
    v_mfma_f32_16x16x32_bf16 v[156:159], v[212:215], v[252:255], v[156:159]
    v_mfma_f32_16x16x32_bf16 v[172:175], v[216:219], v[252:255], v[172:175]
    v_mfma_f32_16x16x32_bf16 v[188:191], v[220:223], v[252:255], v[188:191]
    s_waitcnt vmcnt(9)
    s_waitcnt lgkmcnt(0)
    s_barrier
    v_mfma_f32_16x16x32_bf16 v[46:49], v[224:227], v[224:227], v[46:49]
    s_add_u32 m0, s28, 0
    v_mfma_f32_16x16x32_bf16 v[42:45], v[50:53], v[224:227], v[42:45]
    ds_read_b128 v[240:243], v12 offset:53248
    buffer_load_dwordx4 v24, s[48:51], s68 offen lds
    v_mfma_f32_16x16x32_bf16 v[128:131], v[192:195], v[224:227], v[128:131]
    ds_read_b128 v[244:247], v13 offset:53248
    v_mfma_f32_16x16x32_bf16 v[144:147], v[196:199], v[224:227], v[144:147]
    ds_read_b128 v[248:251], v14 offset:53248
    v_mfma_f32_16x16x32_bf16 v[160:163], v[200:203], v[224:227], v[160:163]
    ds_read_b128 v[252:255], v15 offset:53248
    buffer_load_dwordx4 v25, s[48:51], s68 offen offset:1024 lds
    v_mfma_f32_16x16x32_bf16 v[176:179], v[204:207], v[224:227], v[176:179]
    ds_read_b64_tr_b16 v[208:209], v16 offset:4096
    v_mfma_f32_16x16x32_bf16 v[132:135], v[192:195], v[228:231], v[132:135]
    ds_read_b64_tr_b16 v[210:211], v16 offset:6144
    ds_read_b64_tr_b16 a[128:129], v28 offset:8192
    v_mfma_f32_16x16x32_bf16 v[148:151], v[196:199], v[228:231], v[148:151]
    ds_read_b64_tr_b16 v[212:213], v17 offset:4096
    ds_read_b64_tr_b16 a[130:131], v28 offset:10240
    v_mfma_f32_16x16x32_bf16 v[164:167], v[200:203], v[228:231], v[164:167]
    ds_read_b64_tr_b16 v[214:215], v17 offset:6144
    v_mfma_f32_16x16x32_bf16 v[180:183], v[204:207], v[228:231], v[180:183]
    ds_read_b64_tr_b16 v[216:217], v18 offset:4096
    buffer_load_dwordx4 v26, s[48:51], s68 offen offset:2048 lds
    v_mfma_f32_16x16x32_bf16 v[136:139], v[192:195], v[232:235], v[136:139]
    ds_read_b64_tr_b16 v[218:219], v18 offset:6144
    ds_read_b64_tr_b16 a[132:133], v28 offset:12288
    v_mfma_f32_16x16x32_bf16 v[152:155], v[196:199], v[232:235], v[152:155]
    ds_read_b64_tr_b16 v[220:221], v19 offset:4096
    v_mfma_f32_16x16x32_bf16 v[168:171], v[200:203], v[232:235], v[168:171]
    ds_read_b64_tr_b16 v[222:223], v19 offset:6144
    ds_read_b64_tr_b16 a[134:135], v28 offset:14336
    v_mfma_f32_16x16x32_bf16 v[184:187], v[204:207], v[232:235], v[184:187]
    buffer_load_dwordx4 v27, s[48:51], s68 offen offset:3072 lds
    v_mfma_f32_16x16x32_bf16 v[140:143], v[192:195], v[236:239], v[140:143]
    ds_read_b64_tr_b16 a[136:137], v28 offset:32768
    v_mfma_f32_16x16x32_bf16 v[156:159], v[196:199], v[236:239], v[156:159]
    ds_read_b64_tr_b16 a[138:139], v28 offset:34816
    v_mfma_f32_16x16x32_bf16 v[172:175], v[200:203], v[236:239], v[172:175]
    ds_read_b64_tr_b16 a[140:141], v28 offset:36864
    v_mfma_f32_16x16x32_bf16 v[188:191], v[204:207], v[236:239], v[188:191]
    ds_read_b64_tr_b16 a[142:143], v28 offset:38912
    s_waitcnt lgkmcnt(5)
    v_mfma_f32_16x16x32_bf16 v[46:49], v[240:243], v[240:243], v[46:49]
    s_add_u32 m0, s28, 4096
    s_add_u32 s95, s68, 28672
    v_mfma_f32_16x16x32_bf16 v[42:45], v[50:53], v[240:243], v[42:45]
    ds_read_b64_tr_b16 a[144:145], v29 offset:8192
    buffer_load_dwordx4 v24, s[48:51], s95 offen lds
    v_mfma_f32_16x16x32_bf16 v[128:131], v[208:211], v[240:243], v[128:131]
    ds_read_b64_tr_b16 a[146:147], v29 offset:10240
    ds_read_b64_tr_b16 a[148:149], v29 offset:12288
    v_mfma_f32_16x16x32_bf16 v[144:147], v[212:215], v[240:243], v[144:147]
    ds_read_b64_tr_b16 a[150:151], v29 offset:14336
    ds_read_b64_tr_b16 a[152:153], v29 offset:32768
    v_mfma_f32_16x16x32_bf16 v[160:163], v[216:219], v[240:243], v[160:163]
    ds_read_b64_tr_b16 a[154:155], v29 offset:34816
    ds_read_b64_tr_b16 a[156:157], v29 offset:36864
    v_mfma_f32_16x16x32_bf16 v[176:179], v[220:223], v[240:243], v[176:179]
    ds_read_b64_tr_b16 a[158:159], v29 offset:38912
    v_mfma_f32_16x16x32_bf16 v[132:135], v[208:211], v[244:247], v[132:135]
    v_cndmask_b32 v46, v46, v47, s[34:35]
    buffer_load_dwordx4 v25, s[48:51], s95 offen offset:1024 lds
    v_mfma_f32_16x16x32_bf16 v[148:151], v[212:215], v[244:247], v[148:151]
    v_mul_f32 v42, 0x3b124925, v42
    v_cndmask_b32 v46, v46, v48, s[36:37]
    v_mfma_f32_16x16x32_bf16 v[164:167], v[216:219], v[244:247], v[164:167]
    v_cndmask_b32 v46, v46, v49, s[38:39]
    v_mfma_f32_16x16x32_bf16 v[180:183], v[220:223], v[244:247], v[180:183]
    v_mul_f32 v46, 0x3b124925, v46
    v_mfma_f32_16x16x32_bf16 v[136:139], v[208:211], v[248:251], v[136:139]
    v_fma_f32 v46, -v42, v42, v46
    buffer_load_dwordx4 v26, s[48:51], s95 offen offset:2048 lds
    v_mfma_f32_16x16x32_bf16 v[152:155], v[212:215], v[248:251], v[152:155]
    v_max_f32 v46, 0, v46
    v_mul_f32 v46, 0x3e800000, v46
    v_mfma_f32_16x16x32_bf16 v[168:171], v[216:219], v[248:251], v[168:171]
    v_add_f32 v46, 0x3727c5ac, v46
    v_mfma_f32_16x16x32_bf16 v[184:187], v[220:223], v[248:251], v[184:187]
    v_rsq_f32 v46, v46
    v_mfma_f32_16x16x32_bf16 v[140:143], v[208:211], v[252:255], v[140:143]
    s_lshl_b32 s6, s3, 6
    buffer_load_dwordx4 v27, s[48:51], s95 offen offset:3072 lds
    v_mfma_f32_16x16x32_bf16 v[156:159], v[212:215], v[252:255], v[156:159]
    s_add_u32 s6, s6, 157696
    v_lshl_add_u32 v4, v1, 2, s6
    v_mfma_f32_16x16x32_bf16 v[172:175], v[216:219], v[252:255], v[172:175]
    v_sub_f32 v42, 0, v42
    v_mfma_f32_16x16x32_bf16 v[188:191], v[220:223], v[252:255], v[188:191]
    v_mul_f32 v46, 0.5, v46
    s_mov_b64 exec, s[32:33]
    ds_write_b32 v4, v42
    ds_write_b32 v4, v42 offset:256
    ds_write_b32 v4, v46 offset:512
    s_mov_b64 exec, -1
    s_waitcnt vmcnt(8)
    s_waitcnt lgkmcnt(0)
    s_barrier
    ds_read_b32 v112, v37 offset:0
    ds_read_b32 v114, v37 offset:64
    ds_read_b32 v116, v37 offset:128
    ds_read_b32 v118, v37 offset:192
    ds_read_b32 v120, v36 offset:512
    ds_read_b32 v121, v36 offset:576
    ds_read_b32 v122, v36 offset:640
    ds_read_b32 v123, v36 offset:704
    s_mov_b64 exec, 0x3f
    buffer_load_dword v11, v10, s[52:55], 0 offen sc1
    s_mov_b64 exec, -1
    v_max3_u32 v4, v64, v65, v66
    v_max3_u32 v4, v4, v67, v68
    v_max3_u32 v4, v4, v69, v70
    v_max3_u32 v4, v4, v71, v72
    v_max3_u32 v4, v4, v73, v74
    v_max3_u32 v4, v4, v75, v76
    v_max3_u32 v4, v4, v77, v78
    v_max_u32 v4, v4, v79
    v_cmp_eq_u32 vcc, -1, v4
    s_nop 1
    s_cmp_eq_u64 vcc, 0
    s_cbranch_scc0 L_slow_14
L_back_15:
    s_waitcnt lgkmcnt(4)
    v_pk_fma_f32 v[128:129], v[64:65], v[112:113], v[128:129] op_sel_hi:[1,0,1]
    v_pk_fma_f32 v[130:131], v[66:67], v[112:113], v[130:131] op_sel_hi:[1,0,1]
    v_pk_fma_f32 v[144:145], v[68:69], v[112:113], v[144:145] op_sel_hi:[1,0,1]
    ds_read_b64_tr_b16 a[160:161], v28 offset:16384
    v_pk_fma_f32 v[146:147], v[70:71], v[112:113], v[146:147] op_sel_hi:[1,0,1]
    v_cvt_pk_bf16_f32 v96, v128, v129
    v_cvt_pk_bf16_f32 v97, v130, v131
    s_add_u32 m0, s28, 8192
    s_nop 0
    buffer_load_dwordx4 v24, s[48:51], s69 offen lds
    v_cvt_pk_bf16_f32 v98, v144, v145
    v_cvt_pk_bf16_f32 v99, v146, v147
    v_pk_max_i16 v96, v96, 0
    ds_read_b64_tr_b16 a[162:163], v28 offset:18432
    v_pk_max_i16 v97, v97, 0
    v_pk_max_i16 v98, v98, 0
    v_pk_max_i16 v99, v99, 0
    ds_write_b128 v54, v[96:99] offset:0
    v_pk_fma_f32 v[160:161], v[72:73], v[112:113], v[160:161] op_sel_hi:[1,0,1]
    v_pk_fma_f32 v[162:163], v[74:75], v[112:113], v[162:163] op_sel_hi:[1,0,1]
    v_pk_fma_f32 v[176:177], v[76:77], v[112:113], v[176:177] op_sel_hi:[1,0,1]
    ds_read_b64_tr_b16 a[164:165], v28 offset:20480
    v_pk_fma_f32 v[178:179], v[78:79], v[112:113], v[178:179] op_sel_hi:[1,0,1]
    v_cvt_pk_bf16_f32 v100, v160, v161
    v_cvt_pk_bf16_f32 v101, v162, v163
    buffer_load_dwordx4 v25, s[48:51], s69 offen offset:1024 lds
    v_cvt_pk_bf16_f32 v102, v176, v177
    v_cvt_pk_bf16_f32 v103, v178, v179
    v_pk_max_i16 v100, v100, 0
    ds_read_b64_tr_b16 a[166:167], v28 offset:22528
    v_pk_max_i16 v101, v101, 0
    v_pk_max_i16 v102, v102, 0
    v_pk_max_i16 v103, v103, 0
    ds_write_b128 v54, v[100:103] offset:4096
    v_pk_fma_f32 v[132:133], v[64:65], v[114:115], v[132:133] op_sel_hi:[1,0,1]
    v_pk_fma_f32 v[134:135], v[66:67], v[114:115], v[134:135] op_sel_hi:[1,0,1]
    v_pk_fma_f32 v[148:149], v[68:69], v[114:115], v[148:149] op_sel_hi:[1,0,1]
    ds_read_b64_tr_b16 a[168:169], v28 offset:40960
    v_pk_fma_f32 v[150:151], v[70:71], v[114:115], v[150:151] op_sel_hi:[1,0,1]
    v_cvt_pk_bf16_f32 v104, v132, v133
    v_cvt_pk_bf16_f32 v105, v134, v135
    buffer_load_dwordx4 v26, s[48:51], s69 offen offset:2048 lds
    v_cvt_pk_bf16_f32 v106, v148, v149
    v_cvt_pk_bf16_f32 v107, v150, v151
    v_pk_max_i16 v104, v104, 0
    ds_read_b64_tr_b16 a[170:171], v28 offset:43008
    v_pk_max_i16 v105, v105, 0
    v_pk_max_i16 v106, v106, 0
    v_pk_max_i16 v107, v107, 0
    ds_write_b128 v55, v[104:107] offset:0
    v_pk_fma_f32 v[164:165], v[72:73], v[114:115], v[164:165] op_sel_hi:[1,0,1]
    v_pk_fma_f32 v[166:167], v[74:75], v[114:115], v[166:167] op_sel_hi:[1,0,1]
    v_pk_fma_f32 v[180:181], v[76:77], v[114:115], v[180:181] op_sel_hi:[1,0,1]
    ds_read_b64_tr_b16 a[172:173], v28 offset:45056
    v_pk_fma_f32 v[182:183], v[78:79], v[114:115], v[182:183] op_sel_hi:[1,0,1]
    v_cvt_pk_bf16_f32 v108, v164, v165
    v_cvt_pk_bf16_f32 v109, v166, v167
    buffer_load_dwordx4 v27, s[48:51], s69 offen offset:3072 lds
    v_cvt_pk_bf16_f32 v110, v180, v181
    v_cvt_pk_bf16_f32 v111, v182, v183
    v_pk_max_i16 v108, v108, 0
    ds_read_b64_tr_b16 a[174:175], v28 offset:47104
    v_pk_max_i16 v109, v109, 0
    v_pk_max_i16 v110, v110, 0
    v_pk_max_i16 v111, v111, 0
    ds_write_b128 v55, v[108:111] offset:4096
    v_pk_fma_f32 v[136:137], v[64:65], v[116:117], v[136:137] op_sel_hi:[1,0,1]
    v_pk_fma_f32 v[138:139], v[66:67], v[116:117], v[138:139] op_sel_hi:[1,0,1]
    v_pk_fma_f32 v[152:153], v[68:69], v[116:117], v[152:153] op_sel_hi:[1,0,1]
    ds_read_b64_tr_b16 a[176:177], v29 offset:16384
    v_pk_fma_f32 v[154:155], v[70:71], v[116:117], v[154:155] op_sel_hi:[1,0,1]
    v_cvt_pk_bf16_f32 v96, v136, v137
    v_cvt_pk_bf16_f32 v97, v138, v139
    s_add_u32 m0, s28, 12288
    s_add_u32 s95, s69, 28672
    buffer_load_dwordx4 v24, s[48:51], s95 offen lds
    v_cvt_pk_bf16_f32 v98, v152, v153
    v_cvt_pk_bf16_f32 v99, v154, v155
    v_pk_max_i16 v96, v96, 0
    ds_read_b64_tr_b16 a[178:179], v29 offset:18432
    v_pk_max_i16 v97, v97, 0
    v_pk_max_i16 v98, v98, 0
    v_pk_max_i16 v99, v99, 0
    ds_write_b128 v56, v[96:99] offset:0
    v_pk_fma_f32 v[168:169], v[72:73], v[116:117], v[168:169] op_sel_hi:[1,0,1]
    v_pk_fma_f32 v[170:171], v[74:75], v[116:117], v[170:171] op_sel_hi:[1,0,1]
    v_pk_fma_f32 v[184:185], v[76:77], v[116:117], v[184:185] op_sel_hi:[1,0,1]
    ds_read_b64_tr_b16 a[180:181], v29 offset:20480
    v_pk_fma_f32 v[186:187], v[78:79], v[116:117], v[186:187] op_sel_hi:[1,0,1]
    v_cvt_pk_bf16_f32 v100, v168, v169
    v_cvt_pk_bf16_f32 v101, v170, v171
    buffer_load_dwordx4 v25, s[48:51], s95 offen offset:1024 lds
    v_cvt_pk_bf16_f32 v102, v184, v185
    v_cvt_pk_bf16_f32 v103, v186, v187
    v_pk_max_i16 v100, v100, 0
    ds_read_b64_tr_b16 a[182:183], v29 offset:22528
    v_pk_max_i16 v101, v101, 0
    v_pk_max_i16 v102, v102, 0
    v_pk_max_i16 v103, v103, 0
    ds_write_b128 v56, v[100:103] offset:4096
    v_pk_fma_f32 v[140:141], v[64:65], v[118:119], v[140:141] op_sel_hi:[1,0,1]
    v_pk_fma_f32 v[142:143], v[66:67], v[118:119], v[142:143] op_sel_hi:[1,0,1]
    v_pk_fma_f32 v[156:157], v[68:69], v[118:119], v[156:157] op_sel_hi:[1,0,1]
    ds_read_b64_tr_b16 a[184:185], v29 offset:40960
    v_pk_fma_f32 v[158:159], v[70:71], v[118:119], v[158:159] op_sel_hi:[1,0,1]
    v_cvt_pk_bf16_f32 v104, v140, v141
    v_cvt_pk_bf16_f32 v105, v142, v143
    buffer_load_dwordx4 v26, s[48:51], s95 offen offset:2048 lds
    v_cvt_pk_bf16_f32 v106, v156, v157
    v_cvt_pk_bf16_f32 v107, v158, v159
    v_pk_max_i16 v104, v104, 0
    ds_read_b64_tr_b16 a[186:187], v29 offset:43008
    v_pk_max_i16 v105, v105, 0
    v_pk_max_i16 v106, v106, 0
    v_pk_max_i16 v107, v107, 0
    ds_write_b128 v57, v[104:107] offset:0
    v_pk_fma_f32 v[172:173], v[72:73], v[118:119], v[172:173] op_sel_hi:[1,0,1]
    v_pk_fma_f32 v[174:175], v[74:75], v[118:119], v[174:175] op_sel_hi:[1,0,1]
    v_pk_fma_f32 v[188:189], v[76:77], v[118:119], v[188:189] op_sel_hi:[1,0,1]
    ds_read_b64_tr_b16 a[188:189], v29 offset:45056
    v_pk_fma_f32 v[190:191], v[78:79], v[118:119], v[190:191] op_sel_hi:[1,0,1]
    v_cvt_pk_bf16_f32 v108, v172, v173
    v_cvt_pk_bf16_f32 v109, v174, v175
    buffer_load_dwordx4 v27, s[48:51], s95 offen offset:3072 lds
    v_cvt_pk_bf16_f32 v110, v188, v189
    v_cvt_pk_bf16_f32 v111, v190, v191
    v_pk_max_i16 v108, v108, 0
    ds_read_b64_tr_b16 a[190:191], v29 offset:47104
    v_pk_max_i16 v109, v109, 0
    v_pk_max_i16 v110, v110, 0
    v_pk_max_i16 v111, v111, 0
    ds_write_b128 v57, v[108:111] offset:4096
    s_waitcnt lgkmcnt(0)
    s_barrier
    ds_read_b128 a[0:3], v30 offset:0
    ds_read_b128 a[4:7], v30 offset:1024
    ds_read_b128 a[8:11], v30 offset:2048
    ds_read_b128 a[12:15], v30 offset:3072
    ds_read_b128 a[16:19], v30 offset:4096
    ds_read_b128 a[20:23], v30 offset:5120
    ds_read_b128 a[24:27], v30 offset:6144
    ds_read_b128 a[28:31], v30 offset:7168
    s_waitcnt lgkmcnt(4)
    v_mfma_f32_16x16x32_bf16 v[128:131], a[128:131], a[0:3], 0
    ds_read_b128 a[32:35], v30 offset:8192
    s_add_u32 m0, s28, 16384
    v_mfma_f32_16x16x32_bf16 v[132:135], a[128:131], a[4:7], 0
    ds_read_b128 a[36:39], v30 offset:9216
    buffer_load_dwordx4 v24, s[48:51], s70 offen lds
    v_mfma_f32_16x16x32_bf16 v[136:139], a[128:131], a[8:11], 0
    ds_read_b128 a[40:43], v30 offset:10240
    buffer_load_dwordx4 v25, s[48:51], s70 offen offset:1024 lds
    v_mfma_f32_16x16x32_bf16 v[140:143], a[128:131], a[12:15], 0
    ds_read_b128 a[44:47], v30 offset:11264
    s_waitcnt lgkmcnt(4)
    v_mfma_f32_16x16x32_bf16 v[128:131], a[132:135], a[16:19], v[128:131]
    ds_read_b128 a[48:51], v30 offset:12288
    buffer_load_dwordx4 v26, s[48:51], s70 offen offset:2048 lds
    v_mfma_f32_16x16x32_bf16 v[132:135], a[132:135], a[20:23], v[132:135]
    ds_read_b128 a[52:55], v30 offset:13312
    v_mfma_f32_16x16x32_bf16 v[136:139], a[132:135], a[24:27], v[136:139]
    ds_read_b128 a[56:59], v30 offset:14336
    v_mfma_f32_16x16x32_bf16 v[140:143], a[132:135], a[28:31], v[140:143]
    ds_read_b128 a[60:63], v30 offset:15360
    s_waitcnt lgkmcnt(4)
    v_mfma_f32_16x16x32_bf16 v[128:131], a[136:139], a[32:35], v[128:131]
    ds_read_b128 a[64:67], v30 offset:16384
    buffer_load_dwordx4 v27, s[48:51], s70 offen offset:3072 lds
    v_mfma_f32_16x16x32_bf16 v[132:135], a[136:139], a[36:39], v[132:135]
    ds_read_b128 a[68:71], v30 offset:17408
    v_mfma_f32_16x16x32_bf16 v[136:139], a[136:139], a[40:43], v[136:139]
    ds_read_b128 a[72:75], v30 offset:18432
    v_mfma_f32_16x16x32_bf16 v[140:143], a[136:139], a[44:47], v[140:143]
    ds_read_b128 a[76:79], v30 offset:19456
    s_waitcnt lgkmcnt(4)
    v_mfma_f32_16x16x32_bf16 v[128:131], a[140:143], a[48:51], v[128:131]
    s_add_u32 m0, s28, 20480
    s_add_u32 s95, s70, 28672
    v_mfma_f32_16x16x32_bf16 v[132:135], a[140:143], a[52:55], v[132:135]
    ds_read_b128 a[80:83], v30 offset:20480
    buffer_load_dwordx4 v24, s[48:51], s95 offen lds
    v_mfma_f32_16x16x32_bf16 v[136:139], a[140:143], a[56:59], v[136:139]
    ds_read_b128 a[84:87], v30 offset:21504
    buffer_load_dwordx4 v25, s[48:51], s95 offen offset:1024 lds
    v_mfma_f32_16x16x32_bf16 v[140:143], a[140:143], a[60:63], v[140:143]
    ds_read_b128 a[88:91], v30 offset:22528
    ds_read_b128 a[92:95], v30 offset:23552
    s_waitcnt lgkmcnt(4)
    v_mfma_f32_16x16x32_bf16 v[128:131], a[144:147], a[64:67], v[128:131]
    ds_read_b128 a[96:99], v30 offset:24576
    buffer_load_dwordx4 v26, s[48:51], s95 offen offset:2048 lds
    v_mfma_f32_16x16x32_bf16 v[132:135], a[144:147], a[68:71], v[132:135]
    ds_read_b128 a[100:103], v30 offset:25600
    v_mfma_f32_16x16x32_bf16 v[136:139], a[144:147], a[72:75], v[136:139]
    ds_read_b128 a[104:107], v30 offset:26624
    v_mfma_f32_16x16x32_bf16 v[140:143], a[144:147], a[76:79], v[140:143]
    ds_read_b128 a[108:111], v30 offset:27648
    s_waitcnt lgkmcnt(4)
    v_mfma_f32_16x16x32_bf16 v[128:131], a[148:151], a[80:83], v[128:131]
    ds_read_b128 a[112:115], v30 offset:28672
    buffer_load_dwordx4 v27, s[48:51], s95 offen offset:3072 lds
    v_mfma_f32_16x16x32_bf16 v[132:135], a[148:151], a[84:87], v[132:135]
    ds_read_b128 a[116:119], v30 offset:29696
    v_mfma_f32_16x16x32_bf16 v[136:139], a[148:151], a[88:91], v[136:139]
    ds_read_b128 a[120:123], v30 offset:30720
    v_mfma_f32_16x16x32_bf16 v[140:143], a[148:151], a[92:95], v[140:143]
    ds_read_b128 a[124:127], v30 offset:31744
    s_waitcnt lgkmcnt(0)
    s_barrier
    v_mfma_f32_16x16x32_bf16 v[128:131], a[152:155], a[96:99], v[128:131]
    s_add_u32 m0, s94, 0
    v_mfma_f32_16x16x32_bf16 v[132:135], a[152:155], a[100:103], v[132:135]
    buffer_load_dwordx4 v24, s[48:51], s71 offen lds
    v_mfma_f32_16x16x32_bf16 v[136:139], a[152:155], a[104:107], v[136:139]
    v_mfma_f32_16x16x32_bf16 v[140:143], a[152:155], a[108:111], v[140:143]
    v_mfma_f32_16x16x32_bf16 v[128:131], a[156:159], a[112:115], v[128:131]
    buffer_load_dwordx4 v25, s[48:51], s71 offen offset:1024 lds
    v_mfma_f32_16x16x32_bf16 v[132:135], a[156:159], a[116:119], v[132:135]
    v_mfma_f32_16x16x32_bf16 v[136:139], a[156:159], a[120:123], v[136:139]
    v_mfma_f32_16x16x32_bf16 v[140:143], a[156:159], a[124:127], v[140:143]
    s_waitcnt vmcnt(18)
    s_mov_b32 s12, 0
    s_mov_b64 exec, 0x3f
L_rd_16:
    v_cmp_ne_u32 vcc, 1, v11
    s_nop 1
    s_cmp_eq_u64 vcc, 0
    s_cbranch_scc1 L_rdd_17
    s_add_u32 s12, s12, 1
    s_cmp_ge_u32 s12, 0x10000
    s_cbranch_scc1 L_rdd_17
    buffer_load_dword v11, v10, s[52:55], 0 offen sc1
    s_waitcnt vmcnt(0)
    s_branch L_rd_16
L_rdd_17:
    s_mov_b64 exec, -1
    v_mfma_f32_16x16x32_bf16 v[144:147], a[160:163], a[0:3], 0
    v_cvt_pk_bf16_f32 v96, v128, v129
    v_mfma_f32_16x16x32_bf16 v[148:151], a[160:163], a[4:7], 0
    v_cvt_pk_bf16_f32 v97, v130, v131
    v_mfma_f32_16x16x32_bf16 v[152:155], a[160:163], a[8:11], 0
    v_cvt_pk_bf16_f32 v98, v132, v133
    v_mfma_f32_16x16x32_bf16 v[156:159], a[160:163], a[12:15], 0
    v_cvt_pk_bf16_f32 v99, v134, v135
    buffer_store_dwordx4 v[96:99], v30, s[52:55], s73 offen offset:0 sc1
    v_cvt_pk_bf16_f32 v100, v136, v137
    v_cvt_pk_bf16_f32 v101, v138, v139
    v_cvt_pk_bf16_f32 v102, v140, v141
    v_cvt_pk_bf16_f32 v103, v142, v143
    buffer_store_dwordx4 v[100:103], v30, s[52:55], s73 offen offset:1024 sc1
    v_mfma_f32_16x16x32_bf16 v[144:147], a[164:167], a[16:19], v[144:147]
    buffer_load_dwordx4 v26, s[48:51], s71 offen offset:2048 lds
    v_mfma_f32_16x16x32_bf16 v[148:151], a[164:167], a[20:23], v[148:151]
    v_mfma_f32_16x16x32_bf16 v[152:155], a[164:167], a[24:27], v[152:155]
    v_mfma_f32_16x16x32_bf16 v[156:159], a[164:167], a[28:31], v[156:159]
    v_mfma_f32_16x16x32_bf16 v[144:147], a[168:171], a[32:35], v[144:147]
    buffer_load_dwordx4 v27, s[48:51], s71 offen offset:3072 lds
    v_mfma_f32_16x16x32_bf16 v[148:151], a[168:171], a[36:39], v[148:151]
    v_mfma_f32_16x16x32_bf16 v[152:155], a[168:171], a[40:43], v[152:155]
    v_mfma_f32_16x16x32_bf16 v[156:159], a[168:171], a[44:47], v[156:159]
    v_mfma_f32_16x16x32_bf16 v[144:147], a[172:175], a[48:51], v[144:147]
    s_add_u32 m0, s94, 4096
    s_add_u32 s95, s71, 28672
    v_mfma_f32_16x16x32_bf16 v[148:151], a[172:175], a[52:55], v[148:151]
    buffer_load_dwordx4 v24, s[48:51], s95 offen lds
    v_mfma_f32_16x16x32_bf16 v[152:155], a[172:175], a[56:59], v[152:155]
    buffer_load_dwordx4 v25, s[48:51], s95 offen offset:1024 lds
    v_mfma_f32_16x16x32_bf16 v[156:159], a[172:175], a[60:63], v[156:159]
    v_mfma_f32_16x16x32_bf16 v[144:147], a[176:179], a[64:67], v[144:147]
    buffer_load_dwordx4 v26, s[48:51], s95 offen offset:2048 lds
    v_mfma_f32_16x16x32_bf16 v[148:151], a[176:179], a[68:71], v[148:151]
    v_mfma_f32_16x16x32_bf16 v[152:155], a[176:179], a[72:75], v[152:155]
    v_mfma_f32_16x16x32_bf16 v[156:159], a[176:179], a[76:79], v[156:159]
    v_mfma_f32_16x16x32_bf16 v[144:147], a[180:183], a[80:83], v[144:147]
    buffer_load_dwordx4 v27, s[48:51], s95 offen offset:3072 lds
    v_mfma_f32_16x16x32_bf16 v[148:151], a[180:183], a[84:87], v[148:151]
    v_mfma_f32_16x16x32_bf16 v[152:155], a[180:183], a[88:91], v[152:155]
    v_mfma_f32_16x16x32_bf16 v[156:159], a[180:183], a[92:95], v[156:159]
    s_barrier
    v_mfma_f32_16x16x32_bf16 v[144:147], a[184:187], a[96:99], v[144:147]
    s_mul_i32 s95, s3, 14336
    s_sub_u32 s95, s72, s95
    s_mul_i32 s96, s3, 6144
    s_add_u32 m0, s96, 32768
    v_mfma_f32_16x16x32_bf16 v[148:151], a[184:187], a[100:103], v[148:151]
    ds_read_b64_tr_b16 v[192:193], v28 offset:0
    buffer_load_dwordx4 v24, s[48:51], s95 offen lds
    v_mfma_f32_16x16x32_bf16 v[152:155], a[184:187], a[104:107], v[152:155]
    ds_read_b64_tr_b16 v[194:195], v28 offset:2048
    v_mfma_f32_16x16x32_bf16 v[156:159], a[184:187], a[108:111], v[156:159]
    v_mfma_f32_16x16x32_bf16 v[144:147], a[188:191], a[112:115], v[144:147]
    ds_read_b64_tr_b16 v[196:197], v28 offset:4096
    buffer_load_dwordx4 v25, s[48:51], s95 offen offset:1024 lds
    v_mfma_f32_16x16x32_bf16 v[148:151], a[188:191], a[116:119], v[148:151]
    ds_read_b64_tr_b16 v[198:199], v28 offset:6144
    v_mfma_f32_16x16x32_bf16 v[152:155], a[188:191], a[120:123], v[152:155]
    v_mfma_f32_16x16x32_bf16 v[156:159], a[188:191], a[124:127], v[156:159]
    s_waitcnt lgkmcnt(2)
    v_mfma_f32_16x16x32_bf16 v[128:131], v[192:195], a[0:3], 0
    ds_read_b64_tr_b16 v[200:201], v28 offset:24576
    v_cvt_pk_bf16_f32 v104, v144, v145
    v_mfma_f32_16x16x32_bf16 v[132:135], v[192:195], a[4:7], 0
    ds_read_b64_tr_b16 v[202:203], v28 offset:26624
    v_cvt_pk_bf16_f32 v105, v146, v147
    v_mfma_f32_16x16x32_bf16 v[136:139], v[192:195], a[8:11], 0
    v_cvt_pk_bf16_f32 v106, v148, v149
    v_mfma_f32_16x16x32_bf16 v[140:143], v[192:195], a[12:15], 0
    v_cvt_pk_bf16_f32 v107, v150, v151
    buffer_store_dwordx4 v[104:107], v30, s[52:55], s74 offen offset:0 sc1
    s_waitcnt lgkmcnt(2)
    v_mfma_f32_16x16x32_bf16 v[128:131], v[196:199], a[16:19], v[128:131]
    ds_read_b64_tr_b16 v[204:205], v28 offset:28672
    v_cvt_pk_bf16_f32 v108, v152, v153
    v_mfma_f32_16x16x32_bf16 v[132:135], v[196:199], a[20:23], v[132:135]
    ds_read_b64_tr_b16 v[206:207], v28 offset:30720
    v_cvt_pk_bf16_f32 v109, v154, v155
    v_mfma_f32_16x16x32_bf16 v[136:139], v[196:199], a[24:27], v[136:139]
    v_cvt_pk_bf16_f32 v110, v156, v157
    v_mfma_f32_16x16x32_bf16 v[140:143], v[196:199], a[28:31], v[140:143]
    v_cvt_pk_bf16_f32 v111, v158, v159
    buffer_store_dwordx4 v[108:111], v30, s[52:55], s74 offen offset:1024 sc1
    s_waitcnt lgkmcnt(2)
    v_mfma_f32_16x16x32_bf16 v[128:131], v[200:203], a[32:35], v[128:131]
    ds_read_b64_tr_b16 v[192:193], v29 offset:0
    buffer_load_dwordx4 v26, s[48:51], s95 offen offset:2048 lds
    v_mfma_f32_16x16x32_bf16 v[132:135], v[200:203], a[36:39], v[132:135]
    ds_read_b64_tr_b16 v[194:195], v29 offset:2048
    v_mfma_f32_16x16x32_bf16 v[136:139], v[200:203], a[40:43], v[136:139]
    v_mfma_f32_16x16x32_bf16 v[140:143], v[200:203], a[44:47], v[140:143]
    s_waitcnt lgkmcnt(2)
    v_mfma_f32_16x16x32_bf16 v[128:131], v[204:207], a[48:51], v[128:131]
    ds_read_b64_tr_b16 v[196:197], v29 offset:4096
    buffer_load_dwordx4 v27, s[48:51], s95 offen offset:3072 lds
    v_mfma_f32_16x16x32_bf16 v[132:135], v[204:207], a[52:55], v[132:135]
    ds_read_b64_tr_b16 v[198:199], v29 offset:6144
    v_mfma_f32_16x16x32_bf16 v[136:139], v[204:207], a[56:59], v[136:139]
    v_mfma_f32_16x16x32_bf16 v[140:143], v[204:207], a[60:63], v[140:143]
    s_waitcnt lgkmcnt(2)
    v_mfma_f32_16x16x32_bf16 v[128:131], v[192:195], a[64:67], v[128:131]
    s_add_u32 s95, s95, 28672
    s_add_u32 m0, s96, 36864
    v_mfma_f32_16x16x32_bf16 v[132:135], v[192:195], a[68:71], v[132:135]
    ds_read_b64_tr_b16 v[200:201], v29 offset:24576
    buffer_load_dwordx4 v24, s[48:51], s95 offen lds
    v_mfma_f32_16x16x32_bf16 v[136:139], v[192:195], a[72:75], v[136:139]
    ds_read_b64_tr_b16 v[202:203], v29 offset:26624
    v_mfma_f32_16x16x32_bf16 v[140:143], v[192:195], a[76:79], v[140:143]
    s_waitcnt lgkmcnt(2)
    v_mfma_f32_16x16x32_bf16 v[128:131], v[196:199], a[80:83], v[128:131]
    ds_read_b64_tr_b16 v[204:205], v29 offset:28672
    buffer_load_dwordx4 v25, s[48:51], s95 offen offset:1024 lds
    v_mfma_f32_16x16x32_bf16 v[132:135], v[196:199], a[84:87], v[132:135]
    ds_read_b64_tr_b16 v[206:207], v29 offset:30720
    v_mfma_f32_16x16x32_bf16 v[136:139], v[196:199], a[88:91], v[136:139]
    v_mfma_f32_16x16x32_bf16 v[140:143], v[196:199], a[92:95], v[140:143]
    s_waitcnt vmcnt(26)
    s_waitcnt lgkmcnt(0)
    s_barrier
    v_mfma_f32_16x16x32_bf16 v[128:131], v[200:203], a[96:99], v[128:131]
    s_mul_i32 s95, s3, 43008
    s_sub_u32 s95, s72, s95
    s_add_u32 s95, s95, 172032
    s_lshl_b32 s96, s3, 11
    s_add_u32 m0, s96, 59392
    v_mfma_f32_16x16x32_bf16 v[132:135], v[200:203], a[100:103], v[132:135]
    ds_read_b64_tr_b16 v[192:193], v28 offset:8192
    buffer_load_dwordx4 v24, s[48:51], s95 offen lds
    v_mfma_f32_16x16x32_bf16 v[136:139], v[200:203], a[104:107], v[136:139]
    ds_read_b64_tr_b16 v[194:195], v28 offset:10240
    v_mfma_f32_16x16x32_bf16 v[140:143], v[200:203], a[108:111], v[140:143]
    v_mfma_f32_16x16x32_bf16 v[128:131], v[204:207], a[112:115], v[128:131]
    ds_read_b64_tr_b16 v[196:197], v28 offset:12288
    buffer_load_dwordx4 v25, s[48:51], s95 offen offset:1024 lds
    v_mfma_f32_16x16x32_bf16 v[132:135], v[204:207], a[116:119], v[132:135]
    ds_read_b64_tr_b16 v[198:199], v28 offset:14336
    v_mfma_f32_16x16x32_bf16 v[136:139], v[204:207], a[120:123], v[136:139]
    v_mfma_f32_16x16x32_bf16 v[140:143], v[204:207], a[124:127], v[140:143]
    s_waitcnt lgkmcnt(2)
    v_mfma_f32_16x16x32_bf16 v[144:147], v[192:195], a[0:3], 0
    ds_read_b64_tr_b16 v[200:201], v28 offset:32768
    v_cvt_pk_bf16_f32 v96, v128, v129
    v_mfma_f32_16x16x32_bf16 v[148:151], v[192:195], a[4:7], 0
    ds_read_b64_tr_b16 v[202:203], v28 offset:34816
    v_cvt_pk_bf16_f32 v97, v130, v131
    v_mfma_f32_16x16x32_bf16 v[152:155], v[192:195], a[8:11], 0
    v_cvt_pk_bf16_f32 v98, v132, v133
    v_mfma_f32_16x16x32_bf16 v[156:159], v[192:195], a[12:15], 0
    v_cvt_pk_bf16_f32 v99, v134, v135
    buffer_store_dwordx4 v[96:99], v30, s[52:55], s75 offen offset:0 sc1
    s_waitcnt lgkmcnt(2)
    v_mfma_f32_16x16x32_bf16 v[144:147], v[196:199], a[16:19], v[144:147]
    ds_read_b64_tr_b16 v[204:205], v28 offset:36864
    v_lshlrev_b32 v4, 2, v2
    v_mfma_f32_16x16x32_bf16 v[148:151], v[196:199], a[20:23], v[148:151]
    ds_read_b64_tr_b16 v[206:207], v28 offset:38912
    v_sub_u32 v4, v1, v4
    v_mfma_f32_16x16x32_bf16 v[152:155], v[196:199], a[24:27], v[152:155]
    v_mov_b32 v5, 0x3f80
    v_mfma_f32_16x16x32_bf16 v[156:159], v[196:199], a[28:31], v[156:159]
    v_mov_b32 v6, 0x3f800000
    s_waitcnt lgkmcnt(2)
    v_mfma_f32_16x16x32_bf16 v[144:147], v[200:203], a[32:35], v[144:147]
    ds_read_b64_tr_b16 v[192:193], v29 offset:8192
    v_mov_b32 v224, 0
    v_mfma_f32_16x16x32_bf16 v[148:151], v[200:203], a[36:39], v[148:151]
    ds_read_b64_tr_b16 v[194:195], v29 offset:10240
    v_mov_b32 v225, 0
    v_mfma_f32_16x16x32_bf16 v[152:155], v[200:203], a[40:43], v[152:155]
    v_mov_b32 v228, 0
    v_mfma_f32_16x16x32_bf16 v[156:159], v[200:203], a[44:47], v[156:159]
    v_mov_b32 v229, 0
    s_waitcnt lgkmcnt(2)
    v_mfma_f32_16x16x32_bf16 v[144:147], v[204:207], a[48:51], v[144:147]
    ds_read_b64_tr_b16 v[196:197], v29 offset:12288
    v_cvt_pk_bf16_f32 v100, v136, v137
    v_mfma_f32_16x16x32_bf16 v[148:151], v[204:207], a[52:55], v[148:151]
    ds_read_b64_tr_b16 v[198:199], v29 offset:14336
    v_cvt_pk_bf16_f32 v101, v138, v139
    v_mfma_f32_16x16x32_bf16 v[152:155], v[204:207], a[56:59], v[152:155]
    v_cvt_pk_bf16_f32 v102, v140, v141
    v_mfma_f32_16x16x32_bf16 v[156:159], v[204:207], a[60:63], v[156:159]
    v_cvt_pk_bf16_f32 v103, v142, v143
    buffer_store_dwordx4 v[100:103], v30, s[52:55], s75 offen offset:1024 sc1
    s_waitcnt lgkmcnt(2)
    v_mfma_f32_16x16x32_bf16 v[144:147], v[192:195], a[64:67], v[144:147]
    ds_read_b64_tr_b16 v[200:201], v29 offset:32768
    v_cmp_eq_u32 vcc, 0, v4
    v_mfma_f32_16x16x32_bf16 v[148:151], v[192:195], a[68:71], v[148:151]
    ds_read_b64_tr_b16 v[202:203], v29 offset:34816
    v_cmp_eq_u32 s[6:7], 1, v4
    v_mfma_f32_16x16x32_bf16 v[152:155], v[192:195], a[72:75], v[152:155]
    v_cndmask_b32 v226, v224, v5, vcc
    v_mfma_f32_16x16x32_bf16 v[156:159], v[192:195], a[76:79], v[156:159]
    v_cndmask_b32 v226, v226, v6, s[6:7]
    s_waitcnt lgkmcnt(2)
    v_mfma_f32_16x16x32_bf16 v[144:147], v[196:199], a[80:83], v[144:147]
    ds_read_b64_tr_b16 v[204:205], v29 offset:36864
    v_cmp_eq_u32 vcc, 2, v4
    v_mfma_f32_16x16x32_bf16 v[148:151], v[196:199], a[84:87], v[148:151]
    ds_read_b64_tr_b16 v[206:207], v29 offset:38912
    v_cmp_eq_u32 s[6:7], 3, v4
    v_mfma_f32_16x16x32_bf16 v[152:155], v[196:199], a[88:91], v[152:155]
    v_cndmask_b32 v227, v224, v5, vcc
    v_mfma_f32_16x16x32_bf16 v[156:159], v[196:199], a[92:95], v[156:159]
    v_cndmask_b32 v227, v227, v6, s[6:7]
    s_waitcnt vmcnt(22)
    s_barrier
    s_waitcnt lgkmcnt(2)
    v_mfma_f32_16x16x32_bf16 v[144:147], v[200:203], a[96:99], v[144:147]
    ds_read_b64_tr_b16 v[192:193], v28 offset:16384
    v_mfma_f32_16x16x32_bf16 v[148:151], v[200:203], a[100:103], v[148:151]
    ds_read_b64_tr_b16 v[194:195], v28 offset:18432
    v_mfma_f32_16x16x32_bf16 v[152:155], v[200:203], a[104:107], v[152:155]
    v_mfma_f32_16x16x32_bf16 v[156:159], v[200:203], a[108:111], v[156:159]
    s_waitcnt lgkmcnt(2)
    v_mfma_f32_16x16x32_bf16 v[144:147], v[204:207], a[112:115], v[144:147]
    ds_read_b64_tr_b16 v[196:197], v28 offset:20480
    v_mfma_f32_16x16x32_bf16 v[148:151], v[204:207], a[116:119], v[148:151]
    ds_read_b64_tr_b16 v[198:199], v28 offset:22528
    v_mfma_f32_16x16x32_bf16 v[152:155], v[204:207], a[120:123], v[152:155]
    v_mfma_f32_16x16x32_bf16 v[156:159], v[204:207], a[124:127], v[156:159]
    v_mov_b32 v112, v120
    v_mov_b32 v114, v121
    v_mov_b32 v116, v122
    v_mov_b32 v118, v123
    s_waitcnt lgkmcnt(2)
    v_mfma_f32_16x16x32_bf16 v[128:131], v[192:195], a[0:3], 0
    ds_read_b64_tr_b16 v[200:201], v28 offset:40960
    v_cvt_pk_bf16_f32 v104, v144, v145
    v_mfma_f32_16x16x32_bf16 v[132:135], v[192:195], a[4:7], 0
    ds_read_b64_tr_b16 v[202:203], v28 offset:43008
    v_cvt_pk_bf16_f32 v105, v146, v147
    v_mfma_f32_16x16x32_bf16 v[136:139], v[192:195], a[8:11], 0
    v_cvt_pk_bf16_f32 v106, v148, v149
    v_mfma_f32_16x16x32_bf16 v[140:143], v[192:195], a[12:15], 0
    v_cvt_pk_bf16_f32 v107, v150, v151
    buffer_store_dwordx4 v[104:107], v30, s[52:55], s76 offen offset:0 sc1
    s_waitcnt lgkmcnt(2)
    v_mfma_f32_16x16x32_bf16 v[128:131], v[196:199], a[16:19], v[128:131]
    ds_read_b64_tr_b16 v[204:205], v28 offset:45056
    v_mul_f32 v80, 0.5, v80
    v_mfma_f32_16x16x32_bf16 v[132:135], v[196:199], a[20:23], v[132:135]
    ds_read_b64_tr_b16 v[206:207], v28 offset:47104
    v_mul_f32 v81, 0.5, v81
    v_mfma_f32_16x16x32_bf16 v[136:139], v[196:199], a[24:27], v[136:139]
    v_mul_f32 v82, 0.5, v82
    v_mfma_f32_16x16x32_bf16 v[140:143], v[196:199], a[28:31], v[140:143]
    v_mul_f32 v83, 0.5, v83
    s_waitcnt lgkmcnt(2)
    v_mfma_f32_16x16x32_bf16 v[128:131], v[200:203], a[32:35], v[128:131]
    ds_read_b64_tr_b16 v[192:193], v29 offset:16384
    v_mul_f32 v84, 0.5, v84
    v_mfma_f32_16x16x32_bf16 v[132:135], v[200:203], a[36:39], v[132:135]
    ds_read_b64_tr_b16 v[194:195], v29 offset:18432
    v_mul_f32 v85, 0.5, v85
    v_mfma_f32_16x16x32_bf16 v[136:139], v[200:203], a[40:43], v[136:139]
    v_mul_f32 v86, 0.5, v86
    v_mfma_f32_16x16x32_bf16 v[140:143], v[200:203], a[44:47], v[140:143]
    v_mul_f32 v87, 0.5, v87
    s_waitcnt lgkmcnt(2)
    v_mfma_f32_16x16x32_bf16 v[128:131], v[204:207], a[48:51], v[128:131]
    ds_read_b64_tr_b16 v[196:197], v29 offset:20480
    v_cvt_pk_bf16_f32 v108, v152, v153
    v_mfma_f32_16x16x32_bf16 v[132:135], v[204:207], a[52:55], v[132:135]
    ds_read_b64_tr_b16 v[198:199], v29 offset:22528
    v_cvt_pk_bf16_f32 v109, v154, v155
    v_mfma_f32_16x16x32_bf16 v[136:139], v[204:207], a[56:59], v[136:139]
    v_cvt_pk_bf16_f32 v110, v156, v157
    v_mfma_f32_16x16x32_bf16 v[140:143], v[204:207], a[60:63], v[140:143]
    v_cvt_pk_bf16_f32 v111, v158, v159
    buffer_store_dwordx4 v[108:111], v30, s[52:55], s76 offen offset:1024 sc1
    s_waitcnt lgkmcnt(2)
    v_mfma_f32_16x16x32_bf16 v[128:131], v[192:195], a[64:67], v[128:131]
    ds_read_b64_tr_b16 v[200:201], v29 offset:40960
    v_mul_f32 v88, 0.5, v88
    v_mfma_f32_16x16x32_bf16 v[132:135], v[192:195], a[68:71], v[132:135]
    ds_read_b64_tr_b16 v[202:203], v29 offset:43008
    v_mul_f32 v89, 0.5, v89
    v_mfma_f32_16x16x32_bf16 v[136:139], v[192:195], a[72:75], v[136:139]
    v_mul_f32 v90, 0.5, v90
    v_mfma_f32_16x16x32_bf16 v[140:143], v[192:195], a[76:79], v[140:143]
    v_mul_f32 v91, 0.5, v91
    s_waitcnt lgkmcnt(2)
    v_mfma_f32_16x16x32_bf16 v[128:131], v[196:199], a[80:83], v[128:131]
    ds_read_b64_tr_b16 v[204:205], v29 offset:45056
    v_mul_f32 v92, 0.5, v92
    v_mfma_f32_16x16x32_bf16 v[132:135], v[196:199], a[84:87], v[132:135]
    ds_read_b64_tr_b16 v[206:207], v29 offset:47104
    v_mul_f32 v93, 0.5, v93
    v_mfma_f32_16x16x32_bf16 v[136:139], v[196:199], a[88:91], v[136:139]
    v_mul_f32 v94, 0.5, v94
    v_mfma_f32_16x16x32_bf16 v[140:143], v[196:199], a[92:95], v[140:143]
    v_mul_f32 v95, 0.5, v95
    s_waitcnt vmcnt(14)
    s_barrier
    s_waitcnt lgkmcnt(2)
    v_mfma_f32_16x16x32_bf16 v[128:131], v[200:203], a[96:99], v[128:131]
    ds_read_b64_tr_b16 v[192:193], v59 offset:0
    v_mfma_f32_16x16x32_bf16 v[132:135], v[200:203], a[100:103], v[132:135]
    ds_read_b64_tr_b16 v[194:195], v59 offset:2048
    v_mfma_f32_16x16x32_bf16 v[136:139], v[200:203], a[104:107], v[136:139]
    v_mfma_f32_16x16x32_bf16 v[140:143], v[200:203], a[108:111], v[140:143]
    s_waitcnt lgkmcnt(2)
    v_mfma_f32_16x16x32_bf16 v[128:131], v[204:207], a[112:115], v[128:131]
    ds_read_b64_tr_b16 v[196:197], v59 offset:4096
    v_mfma_f32_16x16x32_bf16 v[132:135], v[204:207], a[116:119], v[132:135]
    ds_read_b64_tr_b16 v[198:199], v59 offset:6144
    v_mfma_f32_16x16x32_bf16 v[136:139], v[204:207], a[120:123], v[136:139]
    v_mfma_f32_16x16x32_bf16 v[140:143], v[204:207], a[124:127], v[140:143]
    s_waitcnt lgkmcnt(2)
    v_mfma_f32_16x16x32_bf16 v[144:147], v[192:195], a[0:3], 0
    ds_read_b64_tr_b16 v[200:201], v59 offset:8192
    v_cvt_pk_bf16_f32 v96, v128, v129
    v_mfma_f32_16x16x32_bf16 v[148:151], v[192:195], a[4:7], 0
    ds_read_b64_tr_b16 v[202:203], v59 offset:10240
    v_cvt_pk_bf16_f32 v97, v130, v131
    v_mfma_f32_16x16x32_bf16 v[152:155], v[192:195], a[8:11], 0
    v_cvt_pk_bf16_f32 v98, v132, v133
    v_mfma_f32_16x16x32_bf16 v[156:159], v[192:195], a[12:15], 0
    v_cvt_pk_bf16_f32 v99, v134, v135
    buffer_store_dwordx4 v[96:99], v30, s[52:55], s77 offen offset:0 sc1
    s_waitcnt lgkmcnt(2)
    v_mfma_f32_16x16x32_bf16 v[144:147], v[196:199], a[16:19], v[144:147]
    ds_read_b64_tr_b16 v[204:205], v59 offset:12288
    v_mfma_f32_16x16x32_bf16 v[148:151], v[196:199], a[20:23], v[148:151]
    ds_read_b64_tr_b16 v[206:207], v59 offset:14336
    v_mfma_f32_16x16x32_bf16 v[152:155], v[196:199], a[24:27], v[152:155]
    v_mfma_f32_16x16x32_bf16 v[156:159], v[196:199], a[28:31], v[156:159]
    s_waitcnt lgkmcnt(2)
    v_mfma_f32_16x16x32_bf16 v[144:147], v[200:203], a[32:35], v[144:147]
    ds_read_b64_tr_b16 v[192:193], v59 offset:16384
    v_mfma_f32_16x16x32_bf16 v[148:151], v[200:203], a[36:39], v[148:151]
    ds_read_b64_tr_b16 v[194:195], v59 offset:18432
    v_mfma_f32_16x16x32_bf16 v[152:155], v[200:203], a[40:43], v[152:155]
    v_mfma_f32_16x16x32_bf16 v[156:159], v[200:203], a[44:47], v[156:159]
    s_waitcnt lgkmcnt(2)
    v_mfma_f32_16x16x32_bf16 v[144:147], v[204:207], a[48:51], v[144:147]
    ds_read_b64_tr_b16 v[196:197], v59 offset:20480
    v_cvt_pk_bf16_f32 v100, v136, v137
    v_mfma_f32_16x16x32_bf16 v[148:151], v[204:207], a[52:55], v[148:151]
    ds_read_b64_tr_b16 v[198:199], v59 offset:22528
    v_cvt_pk_bf16_f32 v101, v138, v139
    v_mfma_f32_16x16x32_bf16 v[152:155], v[204:207], a[56:59], v[152:155]
    v_cvt_pk_bf16_f32 v102, v140, v141
    v_mfma_f32_16x16x32_bf16 v[156:159], v[204:207], a[60:63], v[156:159]
    v_cvt_pk_bf16_f32 v103, v142, v143
    buffer_store_dwordx4 v[100:103], v30, s[52:55], s77 offen offset:1024 sc1
    s_waitcnt lgkmcnt(2)
    v_mfma_f32_16x16x32_bf16 v[144:147], v[192:195], a[64:67], v[144:147]
    ds_read_b64_tr_b16 v[200:201], v59 offset:24576
    v_mfma_f32_16x16x32_bf16 v[148:151], v[192:195], a[68:71], v[148:151]
    ds_read_b64_tr_b16 v[202:203], v59 offset:26624
    v_mfma_f32_16x16x32_bf16 v[152:155], v[192:195], a[72:75], v[152:155]
    v_mfma_f32_16x16x32_bf16 v[156:159], v[192:195], a[76:79], v[156:159]
    s_waitcnt lgkmcnt(2)
    v_mfma_f32_16x16x32_bf16 v[144:147], v[196:199], a[80:83], v[144:147]
    ds_read_b64_tr_b16 v[204:205], v59 offset:28672
    v_mfma_f32_16x16x32_bf16 v[148:151], v[196:199], a[84:87], v[148:151]
    ds_read_b64_tr_b16 v[206:207], v59 offset:30720
    v_mfma_f32_16x16x32_bf16 v[152:155], v[196:199], a[88:91], v[152:155]
    v_mfma_f32_16x16x32_bf16 v[156:159], v[196:199], a[92:95], v[156:159]
    s_waitcnt vmcnt(6)
    s_barrier
    s_waitcnt lgkmcnt(2)
    v_mfma_f32_16x16x32_bf16 v[144:147], v[200:203], a[96:99], v[144:147]
    ds_read_b64_tr_b16 v[192:193], v59 offset:32768
    v_mfma_f32_16x16x32_bf16 v[148:151], v[200:203], a[100:103], v[148:151]
    ds_read_b64_tr_b16 v[194:195], v59 offset:34816
    v_mfma_f32_16x16x32_bf16 v[152:155], v[200:203], a[104:107], v[152:155]
    v_mfma_f32_16x16x32_bf16 v[156:159], v[200:203], a[108:111], v[156:159]
    s_waitcnt lgkmcnt(2)
    v_mfma_f32_16x16x32_bf16 v[144:147], v[204:207], a[112:115], v[144:147]
    ds_read_b64_tr_b16 v[196:197], v59 offset:36864
    v_mfma_f32_16x16x32_bf16 v[148:151], v[204:207], a[116:119], v[148:151]
    ds_read_b64_tr_b16 v[198:199], v59 offset:38912
    v_mfma_f32_16x16x32_bf16 v[152:155], v[204:207], a[120:123], v[152:155]
    v_mfma_f32_16x16x32_bf16 v[156:159], v[204:207], a[124:127], v[156:159]
    s_waitcnt lgkmcnt(2)
    v_mfma_f32_16x16x32_bf16 v[128:131], v[192:195], a[0:3], 0
    ds_read_b64_tr_b16 v[200:201], v59 offset:40960
    v_cvt_pk_bf16_f32 v104, v144, v145
    v_mfma_f32_16x16x32_bf16 v[132:135], v[192:195], a[4:7], 0
    ds_read_b64_tr_b16 v[202:203], v59 offset:43008
    v_cvt_pk_bf16_f32 v105, v146, v147
    v_mfma_f32_16x16x32_bf16 v[136:139], v[192:195], a[8:11], 0
    v_cvt_pk_bf16_f32 v106, v148, v149
    v_mfma_f32_16x16x32_bf16 v[140:143], v[192:195], a[12:15], 0
    v_cvt_pk_bf16_f32 v107, v150, v151
    buffer_store_dwordx4 v[104:107], v30, s[52:55], s78 offen offset:0 sc1
    s_waitcnt lgkmcnt(2)
    v_mfma_f32_16x16x32_bf16 v[128:131], v[196:199], a[16:19], v[128:131]
    ds_read_b64_tr_b16 v[204:205], v59 offset:45056
    v_mfma_f32_16x16x32_bf16 v[132:135], v[196:199], a[20:23], v[132:135]
    ds_read_b64_tr_b16 v[206:207], v59 offset:47104
    v_mfma_f32_16x16x32_bf16 v[136:139], v[196:199], a[24:27], v[136:139]
    v_mfma_f32_16x16x32_bf16 v[140:143], v[196:199], a[28:31], v[140:143]
    s_waitcnt lgkmcnt(2)
    v_mfma_f32_16x16x32_bf16 v[128:131], v[200:203], a[32:35], v[128:131]
    ds_read_b64_tr_b16 v[192:193], v59 offset:49152
    v_mfma_f32_16x16x32_bf16 v[132:135], v[200:203], a[36:39], v[132:135]
    ds_read_b64_tr_b16 v[194:195], v59 offset:51200
    v_mfma_f32_16x16x32_bf16 v[136:139], v[200:203], a[40:43], v[136:139]
    v_mfma_f32_16x16x32_bf16 v[140:143], v[200:203], a[44:47], v[140:143]
    s_waitcnt lgkmcnt(2)
    v_mfma_f32_16x16x32_bf16 v[128:131], v[204:207], a[48:51], v[128:131]
    ds_read_b64_tr_b16 v[196:197], v59 offset:53248
    v_cvt_pk_bf16_f32 v108, v152, v153
    v_mfma_f32_16x16x32_bf16 v[132:135], v[204:207], a[52:55], v[132:135]
    ds_read_b64_tr_b16 v[198:199], v59 offset:55296
    v_cvt_pk_bf16_f32 v109, v154, v155
    v_mfma_f32_16x16x32_bf16 v[136:139], v[204:207], a[56:59], v[136:139]
    v_cvt_pk_bf16_f32 v110, v156, v157
    v_mfma_f32_16x16x32_bf16 v[140:143], v[204:207], a[60:63], v[140:143]
    v_cvt_pk_bf16_f32 v111, v158, v159
    buffer_store_dwordx4 v[108:111], v30, s[52:55], s78 offen offset:1024 sc1
    s_waitcnt lgkmcnt(2)
    v_mfma_f32_16x16x32_bf16 v[128:131], v[192:195], a[64:67], v[128:131]
    ds_read_b64_tr_b16 v[200:201], v28 offset:0
    v_mfma_f32_16x16x32_bf16 v[132:135], v[192:195], a[68:71], v[132:135]
    ds_read_b64_tr_b16 v[202:203], v28 offset:2048
    v_mfma_f32_16x16x32_bf16 v[136:139], v[192:195], a[72:75], v[136:139]
    v_mfma_f32_16x16x32_bf16 v[140:143], v[192:195], a[76:79], v[140:143]
    s_waitcnt lgkmcnt(2)
    v_mfma_f32_16x16x32_bf16 v[128:131], v[196:199], a[80:83], v[128:131]
    ds_read_b64_tr_b16 v[204:205], v28 offset:4096
    v_mfma_f32_16x16x32_bf16 v[132:135], v[196:199], a[84:87], v[132:135]
    ds_read_b64_tr_b16 v[206:207], v28 offset:6144
    v_mfma_f32_16x16x32_bf16 v[136:139], v[196:199], a[88:91], v[136:139]
    v_mfma_f32_16x16x32_bf16 v[140:143], v[196:199], a[92:95], v[140:143]
    s_waitcnt lgkmcnt(0)
    v_mfma_f32_16x16x32_bf16 v[128:131], v[200:203], a[96:99], v[128:131]
    buffer_load_dwordx4 v[216:219], v30, s[52:55], s84 offen offset:0 sc1
    v_mfma_f32_16x16x32_bf16 v[132:135], v[200:203], a[100:103], v[132:135]
    v_mfma_f32_16x16x32_bf16 v[136:139], v[200:203], a[104:107], v[136:139]
    buffer_load_dwordx4 v[220:223], v30, s[52:55], s84 offen offset:1024 sc1
    v_mfma_f32_16x16x32_bf16 v[140:143], v[200:203], a[108:111], v[140:143]
    v_mfma_f32_16x16x32_bf16 v[128:131], v[204:207], a[112:115], v[128:131]
    buffer_load_dwordx4 v[208:211], v30, s[52:55], s83 offen offset:0 sc1
    v_mfma_f32_16x16x32_bf16 v[132:135], v[204:207], a[116:119], v[132:135]
    v_mfma_f32_16x16x32_bf16 v[136:139], v[204:207], a[120:123], v[136:139]
    buffer_load_dwordx4 v[212:215], v30, s[52:55], s83 offen offset:1024 sc1
    v_mfma_f32_16x16x32_bf16 v[140:143], v[204:207], a[124:127], v[140:143]
    buffer_load_dwordx4 v[184:187], v30, s[52:55], s82 offen offset:0 sc1
    buffer_load_dwordx4 v[188:191], v30, s[52:55], s82 offen offset:1024 sc1
    buffer_load_dwordx4 v[176:179], v30, s[52:55], s81 offen offset:0 sc1
    buffer_load_dwordx4 v[180:183], v30, s[52:55], s81 offen offset:1024 sc1
    buffer_load_dwordx4 v[168:171], v30, s[52:55], s80 offen offset:0 sc1
    buffer_load_dwordx4 v[172:175], v30, s[52:55], s80 offen offset:1024 sc1
    buffer_load_dwordx4 v[160:163], v30, s[52:55], s79 offen offset:0 sc1
    buffer_load_dwordx4 v[164:167], v30, s[52:55], s79 offen offset:1024 sc1
    v_mul_u32_u24 v8, 57344, v1
    v_lshl_add_u32 v8, v2, 3, v8
    s_waitcnt vmcnt(10)
    v_max3_u32 v4, v216, v217, v218
    v_max3_u32 v4, v4, v219, v220
    v_max3_u32 v4, v4, v221, v222
    v_max_u32 v4, v4, v223
    v_cmp_eq_u32 vcc, -1, v4
    s_nop 1
    s_cmp_eq_u64 vcc, 0
    s_cbranch_scc0 L_slow_18
L_back_19:
    v_mfma_f32_16x16x32_bf16 v[128:131], v[226:229], v[216:219], v[128:131]
    v_mfma_f32_16x16x32_bf16 v[132:135], v[224:227], v[216:219], v[132:135]
    v_mfma_f32_16x16x32_bf16 v[136:139], v[226:229], v[220:223], v[136:139]
    v_mfma_f32_16x16x32_bf16 v[140:143], v[224:227], v[220:223], v[140:143]
    s_waitcnt vmcnt(8)
    v_max3_u32 v4, v208, v209, v210
    v_max3_u32 v4, v4, v211, v212
    v_max3_u32 v4, v4, v213, v214
    v_max_u32 v4, v4, v215
    v_cmp_eq_u32 vcc, -1, v4
    s_nop 1
    s_cmp_eq_u64 vcc, 0
    s_cbranch_scc0 L_slow_20
L_back_21:
    v_mfma_f32_16x16x32_bf16 v[128:131], v[226:229], v[208:211], v[128:131]
    v_mfma_f32_16x16x32_bf16 v[132:135], v[224:227], v[208:211], v[132:135]
    v_mfma_f32_16x16x32_bf16 v[136:139], v[226:229], v[212:215], v[136:139]
    v_mfma_f32_16x16x32_bf16 v[140:143], v[224:227], v[212:215], v[140:143]
    s_waitcnt vmcnt(6)
    v_max3_u32 v4, v184, v185, v186
    v_max3_u32 v4, v4, v187, v188
    v_max3_u32 v4, v4, v189, v190
    v_max_u32 v4, v4, v191
    v_cmp_eq_u32 vcc, -1, v4
    s_nop 1
    s_cmp_eq_u64 vcc, 0
    s_cbranch_scc0 L_slow_22
L_back_23:
    v_mfma_f32_16x16x32_bf16 v[128:131], v[226:229], v[184:187], v[128:131]
    v_mfma_f32_16x16x32_bf16 v[132:135], v[224:227], v[184:187], v[132:135]
    v_mfma_f32_16x16x32_bf16 v[136:139], v[226:229], v[188:191], v[136:139]
    v_mfma_f32_16x16x32_bf16 v[140:143], v[224:227], v[188:191], v[140:143]
    s_waitcnt vmcnt(4)
    v_max3_u32 v4, v176, v177, v178
    v_max3_u32 v4, v4, v179, v180
    v_max3_u32 v4, v4, v181, v182
    v_max_u32 v4, v4, v183
    v_cmp_eq_u32 vcc, -1, v4
    s_nop 1
    s_cmp_eq_u64 vcc, 0
    s_cbranch_scc0 L_slow_24
L_back_25:
    v_mfma_f32_16x16x32_bf16 v[128:131], v[226:229], v[176:179], v[128:131]
    v_mfma_f32_16x16x32_bf16 v[132:135], v[224:227], v[176:179], v[132:135]
    v_mfma_f32_16x16x32_bf16 v[136:139], v[226:229], v[180:183], v[136:139]
    v_mfma_f32_16x16x32_bf16 v[140:143], v[224:227], v[180:183], v[140:143]
    s_waitcnt vmcnt(2)
    v_max3_u32 v4, v168, v169, v170
    v_max3_u32 v4, v4, v171, v172
    v_max3_u32 v4, v4, v173, v174
    v_max_u32 v4, v4, v175
    v_cmp_eq_u32 vcc, -1, v4
    s_nop 1
    s_cmp_eq_u64 vcc, 0
    s_cbranch_scc0 L_slow_26
L_back_27:
    v_mfma_f32_16x16x32_bf16 v[128:131], v[226:229], v[168:171], v[128:131]
    v_mfma_f32_16x16x32_bf16 v[132:135], v[224:227], v[168:171], v[132:135]
    v_mfma_f32_16x16x32_bf16 v[136:139], v[226:229], v[172:175], v[136:139]
    v_mfma_f32_16x16x32_bf16 v[140:143], v[224:227], v[172:175], v[140:143]
    s_waitcnt vmcnt(0)
    v_max3_u32 v4, v160, v161, v162
    v_max3_u32 v4, v4, v163, v164
    v_max3_u32 v4, v4, v165, v166
    v_max_u32 v4, v4, v167
    v_cmp_eq_u32 vcc, -1, v4
    s_nop 1
    s_cmp_eq_u64 vcc, 0
    s_cbranch_scc0 L_slow_28
L_back_29:
    v_mfma_f32_16x16x32_bf16 v[128:131], v[226:229], v[160:163], v[128:131]
    v_mfma_f32_16x16x32_bf16 v[132:135], v[224:227], v[160:163], v[132:135]
    v_mfma_f32_16x16x32_bf16 v[136:139], v[226:229], v[164:167], v[136:139]
    v_mfma_f32_16x16x32_bf16 v[140:143], v[224:227], v[164:167], v[140:143]
    s_nop 4
    v_pk_fma_f32 v[128:129], v[128:129], v[112:113], v[80:81] op_sel_hi:[1,0,1]
    v_pk_fma_f32 v[130:131], v[130:131], v[112:113], v[82:83] op_sel_hi:[1,0,1]
    v_cvt_pk_bf16_f32 v96, v128, v129
    v_cvt_pk_bf16_f32 v97, v130, v131
    buffer_store_dwordx2 v[96:97], v8, s[56:59], s86 offen
    v_pk_fma_f32 v[132:133], v[132:133], v[114:115], v[84:85] op_sel_hi:[1,0,1]
    v_pk_fma_f32 v[134:135], v[134:135], v[114:115], v[86:87] op_sel_hi:[1,0,1]
    v_cvt_pk_bf16_f32 v98, v132, v133
    v_cvt_pk_bf16_f32 v99, v134, v135
    buffer_store_dwordx2 v[98:99], v8, s[56:59], s87 offen
    v_pk_fma_f32 v[136:137], v[136:137], v[116:117], v[88:89] op_sel_hi:[1,0,1]
    v_pk_fma_f32 v[138:139], v[138:139], v[116:117], v[90:91] op_sel_hi:[1,0,1]
    v_cvt_pk_bf16_f32 v100, v136, v137
    v_cvt_pk_bf16_f32 v101, v138, v139
    buffer_store_dwordx2 v[100:101], v8, s[56:59], s88 offen
    v_pk_fma_f32 v[140:141], v[140:141], v[118:119], v[92:93] op_sel_hi:[1,0,1]
    v_pk_fma_f32 v[142:143], v[142:143], v[118:119], v[94:95] op_sel_hi:[1,0,1]
    v_cvt_pk_bf16_f32 v102, v140, v141
    v_cvt_pk_bf16_f32 v103, v142, v143
    buffer_store_dwordx2 v[102:103], v8, s[56:59], s89 offen
    s_endpgm
L_cs:
    s_waitcnt lgkmcnt(0)
    s_mov_b32 s44, s28
    s_mov_b32 s45, s29
    s_mov_b32 s46, 0x188000
    s_mov_b32 s47, 0x00020000
    s_mov_b32 s52, s36
    s_mov_b32 s53, s37
    s_mov_b32 s54, 0x10000000
    s_mov_b32 s55, 0x00020000
    s_mov_b32 s60, s34
    s_mov_b32 s61, s35
    s_mov_b32 s62, 0x100
    s_mov_b32 s63, 0x00020000
    s_sub_u32 s6, s2, 224
    s_lshl_b32 s7, s6, 7
    v_and_b32 v1, 15, v9
    v_lshrrev_b32 v2, 4, v9
    v_mul_u32_u24 v3, 3584, v2
    v_lshl_add_u32 v3, v1, 3, v3
    v_and_b32 v6, 63, v9
    v_lshlrev_b32 v6, 2, v6
    v_mov_b32 v7, -1
    s_lshl_b32 s9, s6, 8
    s_add_u32 s9, s9, 2097152
    buffer_store_dword v7, v6, s[52:55], s9 offen sc1
    s_add_u32 s8, s7, 0
    buffer_load_dwordx2 v[16:17], v3, s[44:47], s8 offen
    s_add_u32 s8, s7, 57344
    buffer_load_dwordx2 v[18:19], v3, s[44:47], s8 offen
    s_add_u32 s8, s7, 114688
    buffer_load_dwordx2 v[20:21], v3, s[44:47], s8 offen
    s_add_u32 s8, s7, 172032
    buffer_load_dwordx2 v[22:23], v3, s[44:47], s8 offen
    s_add_u32 s8, s7, 229376
    buffer_load_dwordx2 v[24:25], v3, s[44:47], s8 offen
    s_add_u32 s8, s7, 286720
    buffer_load_dwordx2 v[26:27], v3, s[44:47], s8 offen
    s_add_u32 s8, s7, 344064
    buffer_load_dwordx2 v[28:29], v3, s[44:47], s8 offen
    s_add_u32 s8, s7, 401408
    buffer_load_dwordx2 v[30:31], v3, s[44:47], s8 offen
    s_add_u32 s8, s7, 458752
    buffer_load_dwordx2 v[32:33], v3, s[44:47], s8 offen
    s_add_u32 s8, s7, 516096
    buffer_load_dwordx2 v[34:35], v3, s[44:47], s8 offen
    s_add_u32 s8, s7, 573440
    buffer_load_dwordx2 v[36:37], v3, s[44:47], s8 offen
    s_add_u32 s8, s7, 630784
    buffer_load_dwordx2 v[38:39], v3, s[44:47], s8 offen
    s_add_u32 s8, s7, 688128
    buffer_load_dwordx2 v[40:41], v3, s[44:47], s8 offen
    s_add_u32 s8, s7, 745472
    buffer_load_dwordx2 v[42:43], v3, s[44:47], s8 offen
    s_add_u32 s8, s7, 802816
    buffer_load_dwordx2 v[44:45], v3, s[44:47], s8 offen
    s_add_u32 s8, s7, 860160
    buffer_load_dwordx2 v[46:47], v3, s[44:47], s8 offen
    s_add_u32 s8, s7, 917504
    buffer_load_dwordx2 v[48:49], v3, s[44:47], s8 offen
    s_add_u32 s8, s7, 974848
    buffer_load_dwordx2 v[50:51], v3, s[44:47], s8 offen
    s_add_u32 s8, s7, 1032192
    buffer_load_dwordx2 v[52:53], v3, s[44:47], s8 offen
    s_add_u32 s8, s7, 1089536
    buffer_load_dwordx2 v[54:55], v3, s[44:47], s8 offen
    s_add_u32 s8, s7, 1146880
    buffer_load_dwordx2 v[56:57], v3, s[44:47], s8 offen
    s_add_u32 s8, s7, 1204224
    buffer_load_dwordx2 v[58:59], v3, s[44:47], s8 offen
    s_add_u32 s8, s7, 1261568
    buffer_load_dwordx2 v[60:61], v3, s[44:47], s8 offen
    s_add_u32 s8, s7, 1318912
    buffer_load_dwordx2 v[62:63], v3, s[44:47], s8 offen
    s_add_u32 s8, s7, 1376256
    buffer_load_dwordx2 v[64:65], v3, s[44:47], s8 offen
    s_add_u32 s8, s7, 1433600
    buffer_load_dwordx2 v[66:67], v3, s[44:47], s8 offen
    s_add_u32 s8, s7, 1490944
    buffer_load_dwordx2 v[68:69], v3, s[44:47], s8 offen
    s_add_u32 s8, s7, 1548288
    buffer_load_dwordx2 v[70:71], v3, s[44:47], s8 offen
    s_waitcnt vmcnt(28)
    s_barrier
    s_cmp_eq_u32 s3, 0
    s_cbranch_scc0 L_arr_30
    s_and_b32 s6, s2, 3
    s_lshl_b32 s6, s6, 6
    v_mov_b32 v4, 1
    v_mov_b32 v5, 0
    s_mov_b64 exec, 1
    buffer_atomic_add v4, v5, s[60:63], s6 offen sc1
    s_mov_b64 exec, -1
L_arr_30:
    s_sub_u32 s6, s2, 224
    v_mov_b32 v76, 0
    v_mov_b32 v77, 0
    v_mov_b32 v78, 0
    v_mov_b32 v79, 0
    s_waitcnt vmcnt(27)
    v_lshlrev_b32 v4, 16, v16
    v_and_b32 v5, 0xffff0000, v16
    v_pk_add_f32 v[76:77], v[76:77], v[4:5]
    v_lshlrev_b32 v4, 16, v17
    v_and_b32 v5, 0xffff0000, v17
    v_pk_add_f32 v[78:79], v[78:79], v[4:5]
    s_waitcnt vmcnt(26)
    v_lshlrev_b32 v4, 16, v18
    v_and_b32 v5, 0xffff0000, v18
    v_pk_add_f32 v[76:77], v[76:77], v[4:5]
    v_lshlrev_b32 v4, 16, v19
    v_and_b32 v5, 0xffff0000, v19
    v_pk_add_f32 v[78:79], v[78:79], v[4:5]
    s_waitcnt vmcnt(25)
    v_lshlrev_b32 v4, 16, v20
    v_and_b32 v5, 0xffff0000, v20
    v_pk_add_f32 v[76:77], v[76:77], v[4:5]
    v_lshlrev_b32 v4, 16, v21
    v_and_b32 v5, 0xffff0000, v21
    v_pk_add_f32 v[78:79], v[78:79], v[4:5]
    s_waitcnt vmcnt(24)
    v_lshlrev_b32 v4, 16, v22
    v_and_b32 v5, 0xffff0000, v22
    v_pk_add_f32 v[76:77], v[76:77], v[4:5]
    v_lshlrev_b32 v4, 16, v23
    v_and_b32 v5, 0xffff0000, v23
    v_pk_add_f32 v[78:79], v[78:79], v[4:5]
    s_waitcnt vmcnt(23)
    v_lshlrev_b32 v4, 16, v24
    v_and_b32 v5, 0xffff0000, v24
    v_pk_add_f32 v[76:77], v[76:77], v[4:5]
    v_lshlrev_b32 v4, 16, v25
    v_and_b32 v5, 0xffff0000, v25
    v_pk_add_f32 v[78:79], v[78:79], v[4:5]
    s_waitcnt vmcnt(22)
    v_lshlrev_b32 v4, 16, v26
    v_and_b32 v5, 0xffff0000, v26
    v_pk_add_f32 v[76:77], v[76:77], v[4:5]
    v_lshlrev_b32 v4, 16, v27
    v_and_b32 v5, 0xffff0000, v27
    v_pk_add_f32 v[78:79], v[78:79], v[4:5]
    s_waitcnt vmcnt(21)
    v_lshlrev_b32 v4, 16, v28
    v_and_b32 v5, 0xffff0000, v28
    v_pk_add_f32 v[76:77], v[76:77], v[4:5]
    v_lshlrev_b32 v4, 16, v29
    v_and_b32 v5, 0xffff0000, v29
    v_pk_add_f32 v[78:79], v[78:79], v[4:5]
    s_waitcnt vmcnt(20)
    v_lshlrev_b32 v4, 16, v30
    v_and_b32 v5, 0xffff0000, v30
    v_pk_add_f32 v[76:77], v[76:77], v[4:5]
    v_lshlrev_b32 v4, 16, v31
    v_and_b32 v5, 0xffff0000, v31
    v_pk_add_f32 v[78:79], v[78:79], v[4:5]
    s_waitcnt vmcnt(19)
    v_lshlrev_b32 v4, 16, v32
    v_and_b32 v5, 0xffff0000, v32
    v_pk_add_f32 v[76:77], v[76:77], v[4:5]
    v_lshlrev_b32 v4, 16, v33
    v_and_b32 v5, 0xffff0000, v33
    v_pk_add_f32 v[78:79], v[78:79], v[4:5]
    s_waitcnt vmcnt(18)
    v_lshlrev_b32 v4, 16, v34
    v_and_b32 v5, 0xffff0000, v34
    v_pk_add_f32 v[76:77], v[76:77], v[4:5]
    v_lshlrev_b32 v4, 16, v35
    v_and_b32 v5, 0xffff0000, v35
    v_pk_add_f32 v[78:79], v[78:79], v[4:5]
    s_waitcnt vmcnt(17)
    v_lshlrev_b32 v4, 16, v36
    v_and_b32 v5, 0xffff0000, v36
    v_pk_add_f32 v[76:77], v[76:77], v[4:5]
    v_lshlrev_b32 v4, 16, v37
    v_and_b32 v5, 0xffff0000, v37
    v_pk_add_f32 v[78:79], v[78:79], v[4:5]
    s_waitcnt vmcnt(16)
    v_lshlrev_b32 v4, 16, v38
    v_and_b32 v5, 0xffff0000, v38
    v_pk_add_f32 v[76:77], v[76:77], v[4:5]
    v_lshlrev_b32 v4, 16, v39
    v_and_b32 v5, 0xffff0000, v39
    v_pk_add_f32 v[78:79], v[78:79], v[4:5]
    s_waitcnt vmcnt(15)
    v_lshlrev_b32 v4, 16, v40
    v_and_b32 v5, 0xffff0000, v40
    v_pk_add_f32 v[76:77], v[76:77], v[4:5]
    v_lshlrev_b32 v4, 16, v41
    v_and_b32 v5, 0xffff0000, v41
    v_pk_add_f32 v[78:79], v[78:79], v[4:5]
    s_waitcnt vmcnt(14)
    v_lshlrev_b32 v4, 16, v42
    v_and_b32 v5, 0xffff0000, v42
    v_pk_add_f32 v[76:77], v[76:77], v[4:5]
    v_lshlrev_b32 v4, 16, v43
    v_and_b32 v5, 0xffff0000, v43
    v_pk_add_f32 v[78:79], v[78:79], v[4:5]
    s_waitcnt vmcnt(13)
    v_lshlrev_b32 v4, 16, v44
    v_and_b32 v5, 0xffff0000, v44
    v_pk_add_f32 v[76:77], v[76:77], v[4:5]
    v_lshlrev_b32 v4, 16, v45
    v_and_b32 v5, 0xffff0000, v45
    v_pk_add_f32 v[78:79], v[78:79], v[4:5]
    s_waitcnt vmcnt(12)
    v_lshlrev_b32 v4, 16, v46
    v_and_b32 v5, 0xffff0000, v46
    v_pk_add_f32 v[76:77], v[76:77], v[4:5]
    v_lshlrev_b32 v4, 16, v47
    v_and_b32 v5, 0xffff0000, v47
    v_pk_add_f32 v[78:79], v[78:79], v[4:5]
    s_waitcnt vmcnt(11)
    v_lshlrev_b32 v4, 16, v48
    v_and_b32 v5, 0xffff0000, v48
    v_pk_add_f32 v[76:77], v[76:77], v[4:5]
    v_lshlrev_b32 v4, 16, v49
    v_and_b32 v5, 0xffff0000, v49
    v_pk_add_f32 v[78:79], v[78:79], v[4:5]
    s_waitcnt vmcnt(10)
    v_lshlrev_b32 v4, 16, v50
    v_and_b32 v5, 0xffff0000, v50
    v_pk_add_f32 v[76:77], v[76:77], v[4:5]
    v_lshlrev_b32 v4, 16, v51
    v_and_b32 v5, 0xffff0000, v51
    v_pk_add_f32 v[78:79], v[78:79], v[4:5]
    s_waitcnt vmcnt(9)
    v_lshlrev_b32 v4, 16, v52
    v_and_b32 v5, 0xffff0000, v52
    v_pk_add_f32 v[76:77], v[76:77], v[4:5]
    v_lshlrev_b32 v4, 16, v53
    v_and_b32 v5, 0xffff0000, v53
    v_pk_add_f32 v[78:79], v[78:79], v[4:5]
    s_waitcnt vmcnt(8)
    v_lshlrev_b32 v4, 16, v54
    v_and_b32 v5, 0xffff0000, v54
    v_pk_add_f32 v[76:77], v[76:77], v[4:5]
    v_lshlrev_b32 v4, 16, v55
    v_and_b32 v5, 0xffff0000, v55
    v_pk_add_f32 v[78:79], v[78:79], v[4:5]
    s_waitcnt vmcnt(7)
    v_lshlrev_b32 v4, 16, v56
    v_and_b32 v5, 0xffff0000, v56
    v_pk_add_f32 v[76:77], v[76:77], v[4:5]
    v_lshlrev_b32 v4, 16, v57
    v_and_b32 v5, 0xffff0000, v57
    v_pk_add_f32 v[78:79], v[78:79], v[4:5]
    s_waitcnt vmcnt(6)
    v_lshlrev_b32 v4, 16, v58
    v_and_b32 v5, 0xffff0000, v58
    v_pk_add_f32 v[76:77], v[76:77], v[4:5]
    v_lshlrev_b32 v4, 16, v59
    v_and_b32 v5, 0xffff0000, v59
    v_pk_add_f32 v[78:79], v[78:79], v[4:5]
    s_waitcnt vmcnt(5)
    v_lshlrev_b32 v4, 16, v60
    v_and_b32 v5, 0xffff0000, v60
    v_pk_add_f32 v[76:77], v[76:77], v[4:5]
    v_lshlrev_b32 v4, 16, v61
    v_and_b32 v5, 0xffff0000, v61
    v_pk_add_f32 v[78:79], v[78:79], v[4:5]
    s_waitcnt vmcnt(4)
    v_lshlrev_b32 v4, 16, v62
    v_and_b32 v5, 0xffff0000, v62
    v_pk_add_f32 v[76:77], v[76:77], v[4:5]
    v_lshlrev_b32 v4, 16, v63
    v_and_b32 v5, 0xffff0000, v63
    v_pk_add_f32 v[78:79], v[78:79], v[4:5]
    s_waitcnt vmcnt(3)
    v_lshlrev_b32 v4, 16, v64
    v_and_b32 v5, 0xffff0000, v64
    v_pk_add_f32 v[76:77], v[76:77], v[4:5]
    v_lshlrev_b32 v4, 16, v65
    v_and_b32 v5, 0xffff0000, v65
    v_pk_add_f32 v[78:79], v[78:79], v[4:5]
    s_waitcnt vmcnt(2)
    v_lshlrev_b32 v4, 16, v66
    v_and_b32 v5, 0xffff0000, v66
    v_pk_add_f32 v[76:77], v[76:77], v[4:5]
    v_lshlrev_b32 v4, 16, v67
    v_and_b32 v5, 0xffff0000, v67
    v_pk_add_f32 v[78:79], v[78:79], v[4:5]
    s_waitcnt vmcnt(1)
    v_lshlrev_b32 v4, 16, v68
    v_and_b32 v5, 0xffff0000, v68
    v_pk_add_f32 v[76:77], v[76:77], v[4:5]
    v_lshlrev_b32 v4, 16, v69
    v_and_b32 v5, 0xffff0000, v69
    v_pk_add_f32 v[78:79], v[78:79], v[4:5]
    s_waitcnt vmcnt(0)
    v_lshlrev_b32 v4, 16, v70
    v_and_b32 v5, 0xffff0000, v70
    v_pk_add_f32 v[76:77], v[76:77], v[4:5]
    v_lshlrev_b32 v4, 16, v71
    v_and_b32 v5, 0xffff0000, v71
    v_pk_add_f32 v[78:79], v[78:79], v[4:5]
    v_lshlrev_b32 v4, 8, v2
    v_lshl_add_u32 v4, v1, 4, v4
    ds_write_b128 v4, v[76:79]
    s_waitcnt lgkmcnt(0)
    s_barrier
    v_and_b32 v1, 63, v9
    v_lshlrev_b32 v1, 2, v1
    ds_read_b32 v16, v1 offset:0
    ds_read_b32 v17, v1 offset:256
    ds_read_b32 v18, v1 offset:512
    ds_read_b32 v19, v1 offset:768
    ds_read_b32 v20, v1 offset:1024
    ds_read_b32 v21, v1 offset:1280
    ds_read_b32 v22, v1 offset:1536
    ds_read_b32 v23, v1 offset:1792
    ds_read_b32 v24, v1 offset:2048
    ds_read_b32 v25, v1 offset:2304
    ds_read_b32 v26, v1 offset:2560
    ds_read_b32 v27, v1 offset:2816
    ds_read_b32 v28, v1 offset:3072
    ds_read_b32 v29, v1 offset:3328
    ds_read_b32 v30, v1 offset:3584
    ds_read_b32 v31, v1 offset:3840
    s_waitcnt lgkmcnt(0)
    v_add_f32 v16, v16, v17
    v_add_f32 v16, v16, v18
    v_add_f32 v16, v16, v19
    v_add_f32 v16, v16, v20
    v_add_f32 v16, v16, v21
    v_add_f32 v16, v16, v22
    v_add_f32 v16, v16, v23
    v_add_f32 v16, v16, v24
    v_add_f32 v16, v16, v25
    v_add_f32 v16, v16, v26
    v_add_f32 v16, v16, v27
    v_add_f32 v16, v16, v28
    v_add_f32 v16, v16, v29
    v_add_f32 v16, v16, v30
    v_add_f32 v16, v16, v31
    s_lshl_b32 s7, s6, 8
    s_add_u32 s7, s7, 2097152
    s_cmp_eq_u32 s3, 0
    s_cbranch_scc0 L_csk_31
    buffer_store_dword v16, v1, s[52:55], s7 offen sc1
L_csk_31:
    s_endpgm
L_slow_5:
    s_mov_b32 s12, 0
L_sl_32:
    buffer_load_dwordx2 v[64:65], v31, s[52:55], s24 offen offset:0 sc1
    buffer_load_dwordx2 v[66:67], v31, s[52:55], s24 offen offset:128 sc1
    buffer_load_dwordx2 v[68:69], v31, s[52:55], s24 offen offset:256 sc1
    buffer_load_dwordx2 v[70:71], v31, s[52:55], s24 offen offset:384 sc1
    buffer_load_dwordx2 v[72:73], v31, s[52:55], s24 offen offset:2048 sc1
    buffer_load_dwordx2 v[74:75], v31, s[52:55], s24 offen offset:2176 sc1
    buffer_load_dwordx2 v[76:77], v31, s[52:55], s24 offen offset:2304 sc1
    buffer_load_dwordx2 v[78:79], v31, s[52:55], s24 offen offset:2432 sc1
    s_waitcnt vmcnt(0)
    v_max3_u32 v4, v64, v65, v66
    v_max3_u32 v4, v4, v67, v68
    v_max3_u32 v4, v4, v69, v70
    v_max3_u32 v4, v4, v71, v72
    v_max3_u32 v4, v4, v73, v74
    v_max3_u32 v4, v4, v75, v76
    v_max3_u32 v4, v4, v77, v78
    v_max_u32 v4, v4, v79
    v_cmp_eq_u32 vcc, -1, v4
    s_nop 1
    s_cmp_eq_u64 vcc, 0
    s_cbranch_scc1 L_back_6
    s_add_u32 s12, s12, 1
    s_cmp_lt_u32 s12, 0x4000
    s_cbranch_scc1 L_sl_32
    s_branch L_back_6
L_slow_8:
    s_mov_b32 s12, 0
L_sl_33:
    buffer_load_dwordx2 v[80:81], v31, s[52:55], s25 offen offset:0 sc1
    buffer_load_dwordx2 v[82:83], v31, s[52:55], s25 offen offset:128 sc1
    buffer_load_dwordx2 v[84:85], v31, s[52:55], s25 offen offset:256 sc1
    buffer_load_dwordx2 v[86:87], v31, s[52:55], s25 offen offset:384 sc1
    buffer_load_dwordx2 v[88:89], v31, s[52:55], s25 offen offset:2048 sc1
    buffer_load_dwordx2 v[90:91], v31, s[52:55], s25 offen offset:2176 sc1
    buffer_load_dwordx2 v[92:93], v31, s[52:55], s25 offen offset:2304 sc1
    buffer_load_dwordx2 v[94:95], v31, s[52:55], s25 offen offset:2432 sc1
    s_waitcnt vmcnt(0)
    v_max3_u32 v4, v80, v81, v82
    v_max3_u32 v4, v4, v83, v84
    v_max3_u32 v4, v4, v85, v86
    v_max3_u32 v4, v4, v87, v88
    v_max3_u32 v4, v4, v89, v90
    v_max3_u32 v4, v4, v91, v92
    v_max3_u32 v4, v4, v93, v94
    v_max_u32 v4, v4, v95
    v_cmp_eq_u32 vcc, -1, v4
    s_nop 1
    s_cmp_eq_u64 vcc, 0
    s_cbranch_scc1 L_back_9
    s_add_u32 s12, s12, 1
    s_cmp_lt_u32 s12, 0x4000
    s_cbranch_scc1 L_sl_33
    s_branch L_back_9
L_slow_10:
    s_mov_b32 s12, 0
L_sl_34:
    buffer_load_dwordx2 v[96:97], v31, s[52:55], s26 offen offset:0 sc1
    buffer_load_dwordx2 v[98:99], v31, s[52:55], s26 offen offset:128 sc1
    buffer_load_dwordx2 v[100:101], v31, s[52:55], s26 offen offset:256 sc1
    buffer_load_dwordx2 v[102:103], v31, s[52:55], s26 offen offset:384 sc1
    buffer_load_dwordx2 v[104:105], v31, s[52:55], s26 offen offset:2048 sc1
    buffer_load_dwordx2 v[106:107], v31, s[52:55], s26 offen offset:2176 sc1
    buffer_load_dwordx2 v[108:109], v31, s[52:55], s26 offen offset:2304 sc1
    buffer_load_dwordx2 v[110:111], v31, s[52:55], s26 offen offset:2432 sc1
    s_waitcnt vmcnt(0)
    v_max3_u32 v4, v96, v97, v98
    v_max3_u32 v4, v4, v99, v100
    v_max3_u32 v4, v4, v101, v102
    v_max3_u32 v4, v4, v103, v104
    v_max3_u32 v4, v4, v105, v106
    v_max3_u32 v4, v4, v107, v108
    v_max3_u32 v4, v4, v109, v110
    v_max_u32 v4, v4, v111
    v_cmp_eq_u32 vcc, -1, v4
    s_nop 1
    s_cmp_eq_u64 vcc, 0
    s_cbranch_scc1 L_back_11
    s_add_u32 s12, s12, 1
    s_cmp_lt_u32 s12, 0x4000
    s_cbranch_scc1 L_sl_34
    s_branch L_back_11
L_slow_12:
    s_mov_b32 s12, 0
L_sl_35:
    buffer_load_dwordx2 v[112:113], v31, s[52:55], s27 offen offset:0 sc1
    buffer_load_dwordx2 v[114:115], v31, s[52:55], s27 offen offset:128 sc1
    buffer_load_dwordx2 v[116:117], v31, s[52:55], s27 offen offset:256 sc1
    buffer_load_dwordx2 v[118:119], v31, s[52:55], s27 offen offset:384 sc1
    buffer_load_dwordx2 v[120:121], v31, s[52:55], s27 offen offset:2048 sc1
    buffer_load_dwordx2 v[122:123], v31, s[52:55], s27 offen offset:2176 sc1
    buffer_load_dwordx2 v[124:125], v31, s[52:55], s27 offen offset:2304 sc1
    buffer_load_dwordx2 v[126:127], v31, s[52:55], s27 offen offset:2432 sc1
    s_waitcnt vmcnt(0)
    v_max3_u32 v4, v112, v113, v114
    v_max3_u32 v4, v4, v115, v116
    v_max3_u32 v4, v4, v117, v118
    v_max3_u32 v4, v4, v119, v120
    v_max3_u32 v4, v4, v121, v122
    v_max3_u32 v4, v4, v123, v124
    v_max3_u32 v4, v4, v125, v126
    v_max_u32 v4, v4, v127
    v_cmp_eq_u32 vcc, -1, v4
    s_nop 1
    s_cmp_eq_u64 vcc, 0
    s_cbranch_scc1 L_back_13
    s_add_u32 s12, s12, 1
    s_cmp_lt_u32 s12, 0x4000
    s_cbranch_scc1 L_sl_35
    s_branch L_back_13
L_slow_14:
    s_mov_b32 s12, 0
L_sl_36:
    buffer_load_dwordx4 v[64:67], v31, s[52:55], s97 offen offset:0 sc1
    buffer_load_dwordx4 v[68:71], v31, s[52:55], s97 offen offset:64 sc1
    buffer_load_dwordx4 v[72:75], v31, s[52:55], s97 offen offset:128 sc1
    buffer_load_dwordx4 v[76:79], v31, s[52:55], s97 offen offset:192 sc1
    s_waitcnt vmcnt(0)
    v_max3_u32 v4, v64, v65, v66
    v_max3_u32 v4, v4, v67, v68
    v_max3_u32 v4, v4, v69, v70
    v_max3_u32 v4, v4, v71, v72
    v_max3_u32 v4, v4, v73, v74
    v_max3_u32 v4, v4, v75, v76
    v_max3_u32 v4, v4, v77, v78
    v_max_u32 v4, v4, v79
    v_cmp_eq_u32 vcc, -1, v4
    s_nop 1
    s_cmp_eq_u64 vcc, 0
    s_cbranch_scc1 L_back_15
    s_add_u32 s12, s12, 1
    s_cmp_lt_u32 s12, 0x4000
    s_cbranch_scc1 L_sl_36
    s_branch L_back_15
L_slow_18:
    s_mov_b32 s12, 0
L_sl_37:
    buffer_load_dwordx4 v[216:219], v30, s[52:55], s84 offen offset:0 sc1
    buffer_load_dwordx4 v[220:223], v30, s[52:55], s84 offen offset:1024 sc1
    s_waitcnt vmcnt(0)
    v_max3_u32 v4, v216, v217, v218
    v_max3_u32 v4, v4, v219, v220
    v_max3_u32 v4, v4, v221, v222
    v_max_u32 v4, v4, v223
    v_cmp_eq_u32 vcc, -1, v4
    s_nop 1
    s_cmp_eq_u64 vcc, 0
    s_cbranch_scc1 L_back_19
    s_add_u32 s12, s12, 1
    s_cmp_lt_u32 s12, 0x4000
    s_cbranch_scc1 L_sl_37
    s_branch L_back_19
L_slow_20:
    s_mov_b32 s12, 0
L_sl_38:
    buffer_load_dwordx4 v[208:211], v30, s[52:55], s83 offen offset:0 sc1
    buffer_load_dwordx4 v[212:215], v30, s[52:55], s83 offen offset:1024 sc1
    s_waitcnt vmcnt(0)
    v_max3_u32 v4, v208, v209, v210
    v_max3_u32 v4, v4, v211, v212
    v_max3_u32 v4, v4, v213, v214
    v_max_u32 v4, v4, v215
    v_cmp_eq_u32 vcc, -1, v4
    s_nop 1
    s_cmp_eq_u64 vcc, 0
    s_cbranch_scc1 L_back_21
    s_add_u32 s12, s12, 1
    s_cmp_lt_u32 s12, 0x4000
    s_cbranch_scc1 L_sl_38
    s_branch L_back_21
L_slow_22:
    s_mov_b32 s12, 0
L_sl_39:
    buffer_load_dwordx4 v[184:187], v30, s[52:55], s82 offen offset:0 sc1
    buffer_load_dwordx4 v[188:191], v30, s[52:55], s82 offen offset:1024 sc1
    s_waitcnt vmcnt(0)
    v_max3_u32 v4, v184, v185, v186
    v_max3_u32 v4, v4, v187, v188
    v_max3_u32 v4, v4, v189, v190
    v_max_u32 v4, v4, v191
    v_cmp_eq_u32 vcc, -1, v4
    s_nop 1
    s_cmp_eq_u64 vcc, 0
    s_cbranch_scc1 L_back_23
    s_add_u32 s12, s12, 1
    s_cmp_lt_u32 s12, 0x4000
    s_cbranch_scc1 L_sl_39
    s_branch L_back_23
L_slow_24:
    s_mov_b32 s12, 0
L_sl_40:
    buffer_load_dwordx4 v[176:179], v30, s[52:55], s81 offen offset:0 sc1
    buffer_load_dwordx4 v[180:183], v30, s[52:55], s81 offen offset:1024 sc1
    s_waitcnt vmcnt(0)
    v_max3_u32 v4, v176, v177, v178
    v_max3_u32 v4, v4, v179, v180
    v_max3_u32 v4, v4, v181, v182
    v_max_u32 v4, v4, v183
    v_cmp_eq_u32 vcc, -1, v4
    s_nop 1
    s_cmp_eq_u64 vcc, 0
    s_cbranch_scc1 L_back_25
    s_add_u32 s12, s12, 1
    s_cmp_lt_u32 s12, 0x4000
    s_cbranch_scc1 L_sl_40
    s_branch L_back_25
L_slow_26:
    s_mov_b32 s12, 0
L_sl_41:
    buffer_load_dwordx4 v[168:171], v30, s[52:55], s80 offen offset:0 sc1
    buffer_load_dwordx4 v[172:175], v30, s[52:55], s80 offen offset:1024 sc1
    s_waitcnt vmcnt(0)
    v_max3_u32 v4, v168, v169, v170
    v_max3_u32 v4, v4, v171, v172
    v_max3_u32 v4, v4, v173, v174
    v_max_u32 v4, v4, v175
    v_cmp_eq_u32 vcc, -1, v4
    s_nop 1
    s_cmp_eq_u64 vcc, 0
    s_cbranch_scc1 L_back_27
    s_add_u32 s12, s12, 1
    s_cmp_lt_u32 s12, 0x4000
    s_cbranch_scc1 L_sl_41
    s_branch L_back_27
L_slow_28:
    s_mov_b32 s12, 0
L_sl_42:
    buffer_load_dwordx4 v[160:163], v30, s[52:55], s79 offen offset:0 sc1
    buffer_load_dwordx4 v[164:167], v30, s[52:55], s79 offen offset:1024 sc1
    s_waitcnt vmcnt(0)
    v_max3_u32 v4, v160, v161, v162
    v_max3_u32 v4, v4, v163, v164
    v_max3_u32 v4, v4, v165, v166
    v_max_u32 v4, v4, v167
    v_cmp_eq_u32 vcc, -1, v4
    s_nop 1
    s_cmp_eq_u64 vcc, 0
    s_cbranch_scc1 L_back_29
    s_add_u32 s12, s12, 1
    s_cmp_lt_u32 s12, 0x4000
    s_cbranch_scc1 L_sl_42
    s_branch L_back_29
L_end:
L_code_end:
    s_endpgm

.section .rodata,"a"
.p2align 6
.amdhsa_kernel sequential_preLN__spectral_fnet__dense_activation_relu__prompt_kernel
  .amdhsa_next_free_vgpr 512
  .amdhsa_next_free_sgpr 102
  .amdhsa_accum_offset 256
  .amdhsa_group_segment_fixed_size 0
  .amdhsa_kernarg_size 88
  .amdhsa_user_sgpr_count 2
  .amdhsa_user_sgpr_kernarg_segment_ptr 1
  .amdhsa_system_sgpr_workgroup_id_x 1
  .amdhsa_float_denorm_mode_32 3
.end_amdhsa_kernel
```
